```python
import torch

def _softmax(x, axis=-1):
    return torch.softmax(x, dim=axis)
def _gelu(x):
    return torch.nn.functional.gelu(x, approximate="tanh")
def _silu(x):
    return torch.nn.functional.silu(x)
def _sigmoid(x):
    return torch.sigmoid(x)
def _layernorm(x, axis=-1, eps=1e-5):
    m = x.mean(dim=axis, keepdim=True)
    v = x.var(dim=axis, keepdim=True, unbiased=False)
    return (x - m) / torch.sqrt(v + eps)
def _scatter_add(tgt, idx, src, axis=0):
    return tgt.clone().index_add_(axis, idx, src)
def _segment_sum(src, seg, n):
    out = torch.zeros((n,) + src.shape[1:], dtype=src.dtype)
    return out.index_add_(0, seg, src)
def _pad(x, pw):
    flat = tuple(v for pair in reversed(pw) for v in pair)
    return torch.nn.functional.pad(x, flat)

kernel_name = 'sequential_preLN__linear_attn_block__glu_gated_reglu__prompt'

def setup_inputs():

    _w = (lambda a: (lambda t: t.to(torch.bfloat16) if t.is_floating_point() else t)(torch.as_tensor(a)))
    def _A_setup():
        B, S, D = 1, 2048, 640
        return {
            "x": _w((lambda *s: torch.randn(*s, dtype=torch.bfloat16) * 0.05)(B, S, D)),
            "wqkv": _w((lambda *s: torch.randn(*s, dtype=torch.bfloat16) * 0.05)(D, 3 * D)),
            "wo": _w((lambda *s: torch.randn(*s, dtype=torch.bfloat16) * 0.05)(D, D)),
        }
    _A_in = _A_setup()

    def _B_setup():
        B, S, D, F = 1, 2048, 640, 1536
        return {
            "x": _w((lambda *s: torch.randn(*s, dtype=torch.bfloat16) * 0.05)(B, S, D)),
            "W_gate": _w((lambda *s: torch.randn(*s, dtype=torch.bfloat16) * 0.2)(D, F) * (2.0 / D) ** 0.5),
            "W_up": _w((lambda *s: torch.randn(*s, dtype=torch.bfloat16) * 0.2)(D, F) * (2.0 / D) ** 0.5),
            "W_down": _w((lambda *s: torch.randn(*s, dtype=torch.bfloat16) * 0.2)(F, D) * (1.0 / F) ** 0.5),
        }
    _B_in = _B_setup()

    return {
        "A_x": _A_in["x"],
        "A_wqkv": _A_in["wqkv"],
        "A_wo": _A_in["wo"],
        "B_x": _B_in["x"],
        "B_W_gate": _B_in["W_gate"],
        "B_W_up": _B_in["W_up"],
        "B_W_down": _B_in["W_down"],
    }

def reference(A_x, A_wqkv, A_wo, B_x, B_W_gate, B_W_up, B_W_down):
    def _A_ref(x, wqkv, wo):
        B, S, D = x.shape
        H = 32; Dh = D // H
        qkv = (lambda x, *d: x.permute(*d))((x @ wqkv).reshape(B, S, 3, H, Dh), 2, 0, 3, 1, 4)
        q, k, v = qkv[0], qkv[1], qkv[2]
        phi = lambda t: torch.where(t > 0, t + 1, torch.exp(t)) + 1e-6
        pq, pk = phi(q), phi(k)
        kv = torch.einsum("bhsd,bhse->bhde", pk, v)
        z = torch.einsum("bhsd->bhd", pk)
        num = torch.einsum("bhqd,bhde->bhqe", pq, kv)
        den = torch.einsum("bhqd,bhd->bhq", pq, z)[..., None] + 1e-6
        o = num / den
        return (lambda x, *d: x.permute(*d))(o, 0, 2, 1, 3).reshape(B, S, D) @ wo

    def _B_ref(x, W_gate, W_up, W_down):
        gate = torch.einsum("bsd,df->bsf", x, W_gate)
        up = torch.einsum("bsd,df->bsf", x, W_up)
        gate = gate * (lambda x, dt: x.to(dt))(gate > 0, gate.dtype)
        h = gate * up
        return torch.einsum("bsf,fd->bsd", h, W_down)

    x = A_x
    h = x + _A_ref(_layernorm(x, axis=-1), A_wqkv, A_wo)
    h2 = h + _B_ref(_layernorm(h, axis=-1), B_W_gate, B_W_up, B_W_down)
    return h2
```

```asm
; @launch grid=(256,1,1) block=(512,1,1) lds=163840
.amdgcn_target "amdgcn-amd-amdhsa--gfx950"
.text
.globl sequential_preLN__linear_attn_block__glu_gated_reglu__prompt_kernel
.p2align 8
.type sequential_preLN__linear_attn_block__glu_gated_reglu__prompt_kernel,@function
sequential_preLN__linear_attn_block__glu_gated_reglu__prompt_kernel:
s_cmp_ge_u32 s2, 256
s_cbranch_scc1 Lend
s_load_dwordx16 s[4:19], s[0:1], 0
s_load_dwordx4 s[20:23], s[0:1], 64
v_lshrrev_b32 v1, 6, v0
v_and_b32 v0, 63, v0
v_readfirstlane_b32 s24, v1
v_lshrrev_b32 v1, 4, v0
v_and_b32 v2, 15, v0
v_lshlrev_b32 v3, 4, v0
s_and_b32 s25, s2, 7
s_lshr_b32 s26, s2, 3
s_lshr_b32 s76, s25, 1
s_and_b32 s77, s25, 1
s_and_b32 s78, s24, 3
s_cmp_ge_u32 s26, 24
s_cbranch_scc1 Lhelp
s_mul_i32 s27, s26, 43
s_lshr_b32 s27, s27, 8
s_mul_i32 s28, s27, 6
s_sub_u32 s28, s26, s28
s_lshl2_add_u32 s29, s76, s27
s_lshl2_add_u32 s30, s77, s28
s_lshl1_add_u32 s31, s77, s28
s_sub_u32 s31, s31, 4
s_cmp_lt_u32 s24, 4
s_cbranch_scc1 L1comp
s_and_b32 s33, s78, 1
s_lshl_b32 s33, s33, 2
v_add_u32 v4, s33, v1
v_and_b32 v5, 7, v0
v_xor_b32 v4, v4, v5
v_lshrrev_b32 v5, 3, v0
v_mul_u32_u24 v5, 1280, v5
v_lshl_add_u32 v10, v4, 4, v5
s_mul_i32 s34, s30, 160
s_add_u32 s34, s34, 1280
s_mul_i32 s35, s31, 320
s_cmp_lt_u32 s28, 4
s_cselect_b32 s52, s34, s35
s_cselect_b32 s35, 1120, 0
s_mul_i32 s36, s78, 61440
s_add_u32 s34, s52, s36
s_lshl_b32 s36, s29, 4
s_add_u32 s36, s36, s78
s_mul_i32 s36, s36, 10240
v_mov_b32 v9, s35
s_mul_i32 s50, s27, 15
s_mul_i32 s51, s28, 10
s_add_u32 s50, s50, s51
s_mul_i32 s51, s76, 4
s_add_u32 s50, s50, s51
s_mul_i32 s50, s50, 43
s_lshr_b32 s50, s50, 8
s_cmp_ge_u32 s50, 10
s_cselect_b32 s51, 10, 0
s_sub_u32 s50, s50, s51
s_lshl_b32 s51, s50, 7
s_add_u32 s36, s36, s51
s_mul_i32 s51, s50, 245760
s_add_u32 s34, s34, s51
v_add_u32 v7, 0, v0
v_mul_u32_u24 v4, 3277, v7
v_lshrrev_b32 v4, 16, v4
v_mul_u32_u24 v5, 20, v4
v_sub_u32 v5, v7, v5
v_lshrrev_b32 v6, 2, v4
v_and_b32 v6, 2, v6
v_xor_b32 v5, v5, v6
v_cmp_le_u32 vcc, 10, v5
v_mul_u32_u24 v4, 3840, v4
v_lshl_add_u32 v4, v5, 4, v4
v_cndmask_b32 v6, 0, v9, vcc
v_add_u32 v11, v4, v6
v_add_u32 v7, 64, v0
v_mul_u32_u24 v4, 3277, v7
v_lshrrev_b32 v4, 16, v4
v_mul_u32_u24 v5, 20, v4
v_sub_u32 v5, v7, v5
v_lshrrev_b32 v6, 2, v4
v_and_b32 v6, 2, v6
v_xor_b32 v5, v5, v6
v_cmp_le_u32 vcc, 10, v5
v_mul_u32_u24 v4, 3840, v4
v_lshl_add_u32 v4, v5, 4, v4
v_cndmask_b32 v6, 0, v9, vcc
v_add_u32 v12, v4, v6
v_add_u32 v7, 128, v0
v_mul_u32_u24 v4, 3277, v7
v_lshrrev_b32 v4, 16, v4
v_mul_u32_u24 v5, 20, v4
v_sub_u32 v5, v7, v5
v_lshrrev_b32 v6, 2, v4
v_and_b32 v6, 2, v6
v_xor_b32 v5, v5, v6
v_cmp_le_u32 vcc, 10, v5
v_mul_u32_u24 v4, 3840, v4
v_lshl_add_u32 v4, v5, 4, v4
v_cndmask_b32 v6, 0, v9, vcc
v_add_u32 v13, v4, v6
v_add_u32 v7, 192, v0
v_mul_u32_u24 v4, 3277, v7
v_lshrrev_b32 v4, 16, v4
v_mul_u32_u24 v5, 20, v4
v_sub_u32 v5, v7, v5
v_lshrrev_b32 v6, 2, v4
v_and_b32 v6, 2, v6
v_xor_b32 v5, v5, v6
v_cmp_le_u32 vcc, 10, v5
v_mul_u32_u24 v4, 3840, v4
v_lshl_add_u32 v4, v5, 4, v4
v_cndmask_b32 v6, 0, v9, vcc
v_add_u32 v14, v4, v6
v_add_u32 v7, 256, v0
v_mul_u32_u24 v4, 3277, v7
v_lshrrev_b32 v4, 16, v4
v_mul_u32_u24 v5, 20, v4
v_sub_u32 v5, v7, v5
v_lshrrev_b32 v6, 2, v4
v_and_b32 v6, 2, v6
v_xor_b32 v5, v5, v6
v_cmp_le_u32 vcc, 10, v5
v_mul_u32_u24 v4, 3840, v4
v_lshl_add_u32 v4, v5, 4, v4
v_cndmask_b32 v6, 0, v9, vcc
v_add_u32 v15, v4, v6
s_lshl_b32 s38, s78, 10
s_mul_i32 s39, s78, 5120
s_add_u32 s39, s39, 16384
s_mov_b32 s37, 0
s_mov_b32 s49, 36864
s_waitcnt lgkmcnt(0)
s_mov_b32 s56, s4
s_mov_b32 s57, s5
s_mov_b32 s58, 2621440
s_mov_b32 s59, 0x20000
s_mov_b32 s44, s6
s_mov_b32 s45, s7
s_mov_b32 s46, 2457600
s_mov_b32 s47, 0x20000
L1ld:
s_cmp_lt_u32 s37, 2
s_cbranch_scc1 L1is
s_waitcnt vmcnt(9)
s_barrier
L1is:
s_add_u32 m0, s39, 0
s_add_u32 s48, s36, 0
buffer_load_dwordx4 v11, s[44:47], s34 offen lds
s_add_u32 m0, s38, 0
s_nop 0
buffer_load_dwordx4 v10, s[56:59], s48 offen lds
s_add_u32 m0, s39, 1024
s_add_u32 s48, s36, 40960
buffer_load_dwordx4 v12, s[44:47], s34 offen lds
s_add_u32 m0, s38, 4096
s_nop 0
buffer_load_dwordx4 v10, s[56:59], s48 offen lds
s_add_u32 m0, s39, 2048
s_add_u32 s48, s36, 81920
buffer_load_dwordx4 v13, s[44:47], s34 offen lds
s_add_u32 m0, s38, 8192
s_nop 0
buffer_load_dwordx4 v10, s[56:59], s48 offen lds
s_add_u32 m0, s39, 3072
s_add_u32 s48, s36, 122880
buffer_load_dwordx4 v14, s[44:47], s34 offen lds
s_add_u32 m0, s38, 12288
s_nop 0
buffer_load_dwordx4 v10, s[56:59], s48 offen lds
s_add_u32 m0, s39, 4096
s_add_u32 s48, s36, 163840
buffer_load_dwordx4 v15, s[44:47], s34 offen lds
s_add_u32 s36, s36, 128
s_add_u32 s34, s34, 245760
s_add_u32 s50, s50, 1
s_cmp_eq_u32 s50, 10
s_cselect_b32 s48, 1280, 0
s_cselect_b32 s51, 2457600, 0
s_sub_u32 s36, s36, s48
s_sub_u32 s34, s34, s51
s_cmp_ge_u32 s38, 73728
s_cselect_b32 s48, -73728, s49
s_add_u32 s38, s38, s48
s_add_u32 s39, s39, s48
s_add_u32 s37, s37, 1
s_cmp_lt_u32 s37, 8
s_cbranch_scc1 L1ld
s_mov_b32 s40, s22
s_mov_b32 s41, s23
s_mov_b32 s42, 33554432
s_mov_b32 s43, 0x20000
v_mov_b32 v17, 0
global_load_dword v16, v17, s[20:21] sc1
v_cmp_le_u32 vcc, 32, v0
v_mov_b32 v4, 7680
s_nop 0
v_cndmask_b32 v4, 0, v4, vcc
v_add_u32 v18, v4, v3
v_cmp_le_u32 vcc, 20, v0
v_lshlrev_b32 v9, 1, v9
s_nop 0
v_cndmask_b32 v4, 0, v9, vcc
v_add_u32 v19, v4, v3
s_lshl_b32 s53, s29, 9
s_add_u32 s53, s53, 3538944
s_lshl_b32 s52, s52, 1
s_add_u32 s52, s52, 3571712
s_waitcnt vmcnt(10)
s_barrier
s_add_u32 m0, s39, 0
s_add_u32 s48, s36, 0
buffer_load_dwordx4 v11, s[44:47], s34 offen lds
s_add_u32 m0, s38, 0
s_nop 0
buffer_load_dwordx4 v10, s[56:59], s48 offen lds
s_add_u32 m0, s39, 1024
s_add_u32 s48, s36, 40960
buffer_load_dwordx4 v12, s[44:47], s34 offen lds
s_add_u32 m0, s38, 4096
s_nop 0
buffer_load_dwordx4 v10, s[56:59], s48 offen lds
s_add_u32 m0, s39, 2048
s_add_u32 s48, s36, 81920
buffer_load_dwordx4 v13, s[44:47], s34 offen lds
s_add_u32 m0, s38, 8192
s_nop 0
buffer_load_dwordx4 v10, s[56:59], s48 offen lds
s_add_u32 m0, s39, 3072
s_add_u32 s48, s36, 122880
buffer_load_dwordx4 v14, s[44:47], s34 offen lds
s_add_u32 m0, s38, 12288
s_nop 0
buffer_load_dwordx4 v10, s[56:59], s48 offen lds
s_add_u32 m0, s39, 4096
s_add_u32 s48, s36, 163840
buffer_load_dwordx4 v15, s[44:47], s34 offen lds
s_add_u32 s36, s36, 128
s_add_u32 s34, s34, 245760
s_add_u32 s50, s50, 1
s_cmp_eq_u32 s50, 10
s_cselect_b32 s48, 1280, 0
s_cselect_b32 s51, 2457600, 0
s_sub_u32 s36, s36, s48
s_sub_u32 s34, s34, s51
s_cmp_ge_u32 s38, 73728
s_cselect_b32 s48, -73728, s49
s_add_u32 s38, s38, s48
s_add_u32 s39, s39, s48
s_mov_b32 s54, 0
s_mov_b32 s80, 0
s_waitcnt vmcnt(9)
s_barrier
s_add_u32 m0, s39, 0
s_add_u32 s48, s36, 0
buffer_load_dwordx4 v11, s[44:47], s34 offen lds
s_add_u32 m0, s38, 0
s_nop 0
buffer_load_dwordx4 v10, s[56:59], s48 offen lds
s_add_u32 m0, s39, 1024
s_add_u32 s48, s36, 40960
buffer_load_dwordx4 v12, s[44:47], s34 offen lds
s_add_u32 m0, s38, 4096
s_nop 0
buffer_load_dwordx4 v10, s[56:59], s48 offen lds
s_add_u32 m0, s39, 2048
s_add_u32 s48, s36, 81920
buffer_load_dwordx4 v13, s[44:47], s34 offen lds
s_add_u32 m0, s38, 8192
s_nop 0
buffer_load_dwordx4 v10, s[56:59], s48 offen lds
s_add_u32 m0, s39, 3072
s_add_u32 s48, s36, 122880
buffer_load_dwordx4 v14, s[44:47], s34 offen lds
s_add_u32 m0, s38, 12288
s_nop 0
buffer_load_dwordx4 v10, s[56:59], s48 offen lds
s_add_u32 m0, s39, 4096
s_add_u32 s48, s36, 163840
buffer_load_dwordx4 v15, s[44:47], s34 offen lds
s_add_u32 s36, s36, 128
s_add_u32 s34, s34, 245760
s_add_u32 s50, s50, 1
s_cmp_eq_u32 s50, 10
s_cselect_b32 s48, 1280, 0
s_cselect_b32 s51, 2457600, 0
s_sub_u32 s36, s36, s48
s_sub_u32 s34, s34, s51
s_cmp_ge_u32 s38, 73728
s_cselect_b32 s48, -73728, s49
s_add_u32 s38, s38, s48
s_add_u32 s39, s39, s48
s_mov_b32 s75, 0
s_branch L1psc
L1ps:
global_load_dword v16, v17, s[20:21] sc1
s_waitcnt vmcnt(0)
L1psc:
v_cmp_gt_u32 vcc, 64, v16
s_add_u32 s75, s75, 1
s_cmp_ge_u32 s75, 0x8000
s_cbranch_scc1 L1psd
s_nop 1
s_cbranch_vccnz L1ps
L1psd:
buffer_load_dwordx4 v[20:23], v18, s[40:43], s53 offen sc1
buffer_load_dwordx4 v[24:27], v19, s[40:43], s52 offen sc1
s_add_u32 s52, s52, 7680
buffer_load_dwordx4 v[28:31], v19, s[40:43], s52 offen sc1
s_add_u32 s52, s52, 7680
buffer_load_dwordx4 v[32:35], v19, s[40:43], s52 offen sc1
s_add_u32 s52, s52, 7680
buffer_load_dwordx4 v[36:39], v19, s[40:43], s52 offen sc1
s_add_u32 s52, s52, 7680
buffer_load_dwordx4 v[40:43], v19, s[40:43], s52 offen sc1
s_add_u32 s52, s52, 7680
s_waitcnt vmcnt(15)
s_barrier
s_lshr_b32 s27, s26, 2
s_lshl3_add_u32 s27, s76, s27
s_and_b32 s28, s26, 3
s_lshl2_add_u32 s28, s77, s28
s_lshl2_add_u32 s29, s27, s78
s_lshr_b32 s60, s27, 1
s_and_b32 s61, s26, 7
s_lshl3_add_u32 s61, s77, s61
s_mul_i32 s30, s28, 102400
s_mul_i32 s31, s78, 5120
s_add_u32 s30, s30, s31
s_add_u32 s30, s30, 16777216
s_mul_i32 s31, s78, 10240
s_add_u32 m0, s31, 122880
s_add_u32 s32, s30, 0
buffer_load_dwordx4 v3, s[40:43], s32 offen offset:0 sc1 lds
buffer_load_dwordx4 v3, s[40:43], s32 offen offset:1024 sc1 lds
buffer_load_dwordx4 v3, s[40:43], s32 offen offset:2048 sc1 lds
buffer_load_dwordx4 v3, s[40:43], s32 offen offset:3072 sc1 lds
s_add_u32 m0, s31, 126976
s_add_u32 s32, s32, 4096
buffer_load_dwordx4 v3, s[40:43], s32 offen sc1 lds
s_add_u32 m0, s31, 128000
s_add_u32 s32, s30, 20480
buffer_load_dwordx4 v3, s[40:43], s32 offen offset:0 sc1 lds
buffer_load_dwordx4 v3, s[40:43], s32 offen offset:1024 sc1 lds
buffer_load_dwordx4 v3, s[40:43], s32 offen offset:2048 sc1 lds
buffer_load_dwordx4 v3, s[40:43], s32 offen offset:3072 sc1 lds
s_add_u32 m0, s31, 132096
s_add_u32 s32, s32, 4096
buffer_load_dwordx4 v3, s[40:43], s32 offen sc1 lds
s_waitcnt vmcnt(16)
s_barrier
s_waitcnt vmcnt(10)
v_pk_add_f32 v[24:25], v[24:25], v[28:29]
v_pk_add_f32 v[26:27], v[26:27], v[30:31]
v_pk_add_f32 v[24:25], v[24:25], v[32:33]
v_pk_add_f32 v[26:27], v[26:27], v[34:35]
v_pk_add_f32 v[24:25], v[24:25], v[36:37]
v_pk_add_f32 v[26:27], v[26:27], v[38:39]
v_pk_add_f32 v[24:25], v[24:25], v[40:41]
v_pk_add_f32 v[26:27], v[26:27], v[42:43]
ds_write_b128 v3, v[20:23] offset:36864
ds_write_b128 v3, v[24:27] offset:37888
v_mov_b32 v4, 45312
v_mov_b32 v6, 0
v_mov_b32 v7, 0
ds_write_b64 v4, v[6:7]
s_waitcnt lgkmcnt(0)
s_barrier
s_mul_i32 s31, s78, 15360
s_add_u32 m0, s31, 61440
s_add_u32 s32, s30, 40960
buffer_load_dwordx4 v3, s[40:43], s32 offen offset:0 sc1 lds
buffer_load_dwordx4 v3, s[40:43], s32 offen offset:1024 sc1 lds
buffer_load_dwordx4 v3, s[40:43], s32 offen offset:2048 sc1 lds
buffer_load_dwordx4 v3, s[40:43], s32 offen offset:3072 sc1 lds
s_add_u32 m0, s31, 65536
s_add_u32 s32, s32, 4096
buffer_load_dwordx4 v3, s[40:43], s32 offen sc1 lds
s_add_u32 m0, s31, 66560
s_add_u32 s32, s30, 61440
buffer_load_dwordx4 v3, s[40:43], s32 offen offset:0 sc1 lds
buffer_load_dwordx4 v3, s[40:43], s32 offen offset:1024 sc1 lds
buffer_load_dwordx4 v3, s[40:43], s32 offen offset:2048 sc1 lds
buffer_load_dwordx4 v3, s[40:43], s32 offen offset:3072 sc1 lds
s_add_u32 m0, s31, 70656
s_add_u32 s32, s32, 4096
buffer_load_dwordx4 v3, s[40:43], s32 offen sc1 lds
s_add_u32 m0, s31, 71680
s_add_u32 s32, s30, 81920
buffer_load_dwordx4 v3, s[40:43], s32 offen offset:0 sc1 lds
buffer_load_dwordx4 v3, s[40:43], s32 offen offset:1024 sc1 lds
buffer_load_dwordx4 v3, s[40:43], s32 offen offset:2048 sc1 lds
buffer_load_dwordx4 v3, s[40:43], s32 offen offset:3072 sc1 lds
s_add_u32 m0, s31, 75776
s_add_u32 s32, s32, 4096
buffer_load_dwordx4 v3, s[40:43], s32 offen sc1 lds
s_barrier
s_branch LX2
L1comp:
s_getpc_b64 s[56:57]
Lpc:
s_lshl2_add_u32 s33, s26, s24
s_lshl_b32 s33, s33, 7
s_min_u32 s34, s33, Lend-Lpc
s_load_dword s58, s[56:57], s34
s_add_u32 s33, s33, 12288
s_min_u32 s34, s33, Lend-Lpc
s_load_dword s58, s[56:57], s34
s_add_u32 s33, s33, 12288
s_min_u32 s34, s33, Lend-Lpc
s_load_dword s58, s[56:57], s34
s_add_u32 s33, s33, 12288
s_lshl_b32 s54, s30, 7
s_lshl_b32 s55, s29, 7
s_add_u32 s55, s55, 1056
s_cmp_lt_u32 s28, 4
s_cselect_b32 s54, s54, s55
s_lshl2_add_u32 s80, s30, 3671040
s_add_u32 s54, s54, 3670016
s_lshl_b32 s32, s24, 12
v_lshrrev_b32 v8, 1, v2
v_xor_b32 v8, v8, v1
v_lshlrev_b32 v8, 4, v8
v_lshl_add_u32 v8, v2, 7, v8
v_add_u32 v4, s32, v8
v_xor_b32 v5, 64, v4
v_lshrrev_b32 v9, 2, v2
v_lshl_add_u32 v9, v1, 3, v9
v_mul_u32_u24 v9, 320, v9
v_and_b32 v8, 3, v0
v_lshl_add_u32 v9, v8, 3, v9
v_add_u32 v9, 16384, v9
v_and_b32 v8, 1, v1
v_lshlrev_b32 v8, 5, v8
v_add_u32 v6, v9, v8
v_sub_u32 v7, v9, v8
v_mov_b32 v28, 0x3f803f80
v_mov_b32 v29, 0x3f803f80
v_mov_b32 v30, 0x3f803f80
v_mov_b32 v31, 0x3f803f80
v_mov_b32 v128, 0
v_mov_b32 v129, 0
v_mov_b32 v130, 0
v_mov_b32 v131, 0
v_mov_b32 v132, 0
v_mov_b32 v133, 0
v_mov_b32 v134, 0
v_mov_b32 v135, 0
v_mov_b32 v136, 0
v_mov_b32 v137, 0
v_mov_b32 v138, 0
v_mov_b32 v139, 0
v_mov_b32 v140, 0
v_mov_b32 v141, 0
v_mov_b32 v142, 0
v_mov_b32 v143, 0
v_mov_b32 v144, 0
v_mov_b32 v145, 0
v_mov_b32 v146, 0
v_mov_b32 v147, 0
v_mov_b32 v148, 0
v_mov_b32 v149, 0
v_mov_b32 v150, 0
v_mov_b32 v151, 0
v_mov_b32 v152, 0
v_mov_b32 v153, 0
v_mov_b32 v154, 0
v_mov_b32 v155, 0
v_mov_b32 v156, 0
v_mov_b32 v157, 0
v_mov_b32 v158, 0
v_mov_b32 v159, 0
v_mov_b32 v160, 0
v_mov_b32 v161, 0
v_mov_b32 v162, 0
v_mov_b32 v163, 0
v_mov_b32 v164, 0
v_mov_b32 v165, 0
v_mov_b32 v166, 0
v_mov_b32 v167, 0
v_mov_b32 v168, 0
v_mov_b32 v169, 0
v_mov_b32 v170, 0
v_mov_b32 v171, 0
v_mov_b32 v172, 0
v_mov_b32 v173, 0
v_mov_b32 v174, 0
v_mov_b32 v175, 0
v_mov_b32 v176, 0
v_mov_b32 v177, 0
v_mov_b32 v178, 0
v_mov_b32 v179, 0
v_mov_b32 v180, 0
v_mov_b32 v181, 0
v_mov_b32 v182, 0
v_mov_b32 v183, 0
v_mov_b32 v184, 0
v_mov_b32 v185, 0
v_mov_b32 v186, 0
v_mov_b32 v187, 0
v_mov_b32 v188, 0
v_mov_b32 v189, 0
v_mov_b32 v190, 0
v_mov_b32 v191, 0
v_mov_b32 v192, 0
v_mov_b32 v193, 0
v_mov_b32 v194, 0
v_mov_b32 v195, 0
v_mov_b32 v196, 0
v_mov_b32 v197, 0
v_mov_b32 v198, 0
v_mov_b32 v199, 0
v_mov_b32 v200, 0
v_mov_b32 v201, 0
v_mov_b32 v202, 0
v_mov_b32 v203, 0
v_mov_b32 v204, 0
v_mov_b32 v205, 0
v_mov_b32 v206, 0
v_mov_b32 v207, 0
s_lshl_b32 s33, s24, 13
v_add_u32 v10, s33, v3
v_add_u32 v10, 6784, v10
v_add_u32 v11, 0, v1
v_mul_u32_u24 v12, 52, v11
v_lshrrev_b32 v12, 8, v12
v_mul_u32_u24 v12, 20, v12
v_sub_u32 v12, v2, v12
v_mul_u32_u24 v11, 336, v11
v_add_u32 v11, s33, v11
v_cmp_eq_u32 vcc, 0, v2
v_add_u32 v13, 320, v11
s_nop 0
v_cndmask_b32 v249, v10, v13, vcc
v_add_u32 v13, 0, v12
v_cmp_gt_u32 vcc, 20, v13
v_lshl_add_u32 v13, v13, 4, v11
s_nop 0
v_cndmask_b32 v236, v10, v13, vcc
v_add_u32 v13, 16, v12
v_cmp_gt_u32 vcc, 20, v13
v_lshl_add_u32 v13, v13, 4, v11
s_nop 0
v_cndmask_b32 v237, v10, v13, vcc
v_add_u32 v11, 4, v1
v_mul_u32_u24 v12, 52, v11
v_lshrrev_b32 v12, 8, v12
v_mul_u32_u24 v12, 20, v12
v_sub_u32 v12, v2, v12
v_mul_u32_u24 v11, 336, v11
v_add_u32 v11, s33, v11
v_cmp_eq_u32 vcc, 0, v2
v_add_u32 v13, 320, v11
s_nop 0
v_cndmask_b32 v250, v10, v13, vcc
v_add_u32 v13, 0, v12
v_cmp_gt_u32 vcc, 20, v13
v_lshl_add_u32 v13, v13, 4, v11
s_nop 0
v_cndmask_b32 v238, v10, v13, vcc
v_add_u32 v13, 16, v12
v_cmp_gt_u32 vcc, 20, v13
v_lshl_add_u32 v13, v13, 4, v11
s_nop 0
v_cndmask_b32 v239, v10, v13, vcc
v_add_u32 v13, 32, v12
v_cmp_gt_u32 vcc, 20, v13
v_lshl_add_u32 v13, v13, 4, v11
s_nop 0
v_cndmask_b32 v240, v10, v13, vcc
v_add_u32 v11, 8, v1
v_mul_u32_u24 v12, 52, v11
v_lshrrev_b32 v12, 8, v12
v_mul_u32_u24 v12, 20, v12
v_sub_u32 v12, v2, v12
v_mul_u32_u24 v11, 336, v11
v_add_u32 v11, s33, v11
v_cmp_eq_u32 vcc, 0, v2
v_add_u32 v13, 320, v11
s_nop 0
v_cndmask_b32 v251, v10, v13, vcc
v_add_u32 v13, 16, v12
v_cmp_gt_u32 vcc, 20, v13
v_lshl_add_u32 v13, v13, 4, v11
s_nop 0
v_cndmask_b32 v241, v10, v13, vcc
v_add_u32 v13, 32, v12
v_cmp_gt_u32 vcc, 20, v13
v_lshl_add_u32 v13, v13, 4, v11
s_nop 0
v_cndmask_b32 v242, v10, v13, vcc
v_add_u32 v13, 48, v12
v_cmp_gt_u32 vcc, 20, v13
v_lshl_add_u32 v13, v13, 4, v11
s_nop 0
v_cndmask_b32 v243, v10, v13, vcc
v_add_u32 v11, 12, v1
v_mul_u32_u24 v12, 52, v11
v_lshrrev_b32 v12, 8, v12
v_mul_u32_u24 v12, 20, v12
v_sub_u32 v12, v2, v12
v_mul_u32_u24 v11, 336, v11
v_add_u32 v11, s33, v11
v_cmp_eq_u32 vcc, 0, v2
v_add_u32 v13, 320, v11
s_nop 0
v_cndmask_b32 v252, v10, v13, vcc
v_add_u32 v13, 32, v12
v_cmp_gt_u32 vcc, 20, v13
v_lshl_add_u32 v13, v13, 4, v11
s_nop 0
v_cndmask_b32 v244, v10, v13, vcc
v_add_u32 v13, 48, v12
v_cmp_gt_u32 vcc, 20, v13
v_lshl_add_u32 v13, v13, 4, v11
s_nop 0
v_cndmask_b32 v245, v10, v13, vcc
v_add_u32 v13, 64, v12
v_cmp_gt_u32 vcc, 20, v13
v_lshl_add_u32 v13, v13, 4, v11
s_nop 0
v_cndmask_b32 v246, v10, v13, vcc
v_add_u32 v11, 16, v1
v_mul_u32_u24 v12, 52, v11
v_lshrrev_b32 v12, 8, v12
v_mul_u32_u24 v12, 20, v12
v_sub_u32 v12, v2, v12
v_mul_u32_u24 v11, 336, v11
v_add_u32 v11, s33, v11
v_cmp_eq_u32 vcc, 0, v2
v_add_u32 v13, 320, v11
s_nop 0
v_cndmask_b32 v253, v10, v13, vcc
v_add_u32 v13, 48, v12
v_cmp_gt_u32 vcc, 20, v13
v_lshl_add_u32 v13, v13, 4, v11
s_nop 0
v_cndmask_b32 v247, v10, v13, vcc
v_add_u32 v13, 64, v12
v_cmp_gt_u32 vcc, 20, v13
v_lshl_add_u32 v13, v13, 4, v11
s_nop 0
v_cndmask_b32 v248, v10, v13, vcc
s_waitcnt lgkmcnt(0)
s_mov_b32 s40, s22
s_mov_b32 s41, s23
s_mov_b32 s42, 33554432
s_mov_b32 s43, 0x20000
s_mul_i32 s33, s30, 6720
s_add_u32 s33, s33, 3145728
s_add_u32 s44, s22, s33
s_addc_u32 s45, s23, 0
s_mov_b32 s46, 6720
s_mov_b32 s47, 0x20000
s_mov_b64 exec, 0
s_cmp_ge_u32 s28, 4
s_cbranch_scc1 Ldq0
s_cmp_eq_u32 s78, 0
s_cbranch_scc1 Ldk00
s_cmp_eq_u32 s78, 1
s_cbranch_scc1 Ldk01
s_cmp_eq_u32 s78, 2
s_cbranch_scc1 Ldk02
s_branch Ldk03
Ldq0:
s_cmp_eq_u32 s78, 0
s_cbranch_scc1 Ldq00
s_cmp_eq_u32 s78, 1
s_cbranch_scc1 Ldq01
s_cmp_eq_u32 s78, 2
s_cbranch_scc1 Ldq02
s_branch Ldq03
Ldr0:
s_mov_b64 exec, -1
s_mov_b64 exec, 0
s_cmp_ge_u32 s28, 4
s_cbranch_scc1 Ldq1
s_cmp_eq_u32 s78, 0
s_cbranch_scc1 Ldk10
s_cmp_eq_u32 s78, 1
s_cbranch_scc1 Ldk11
s_cmp_eq_u32 s78, 2
s_cbranch_scc1 Ldk12
s_branch Ldk13
Ldq1:
s_cmp_eq_u32 s78, 0
s_cbranch_scc1 Ldq10
s_cmp_eq_u32 s78, 1
s_cbranch_scc1 Ldq11
s_cmp_eq_u32 s78, 2
s_cbranch_scc1 Ldq12
s_branch Ldq13
Ldr1:
s_mov_b64 exec, -1
s_mov_b64 exec, 0
s_cmp_eq_u32 s78, 0
s_cbranch_scc1 Ldp20
s_cmp_eq_u32 s78, 1
s_cbranch_scc1 Ldp21
s_cmp_eq_u32 s78, 2
s_cbranch_scc1 Ldp22
s_branch Ldp23
Ldr2:
s_mov_b64 exec, -1
s_mov_b32 s37, 0
s_mov_b32 s38, 0
s_mov_b32 s49, 36864
s_mov_b32 s51, 0x3fb8aa3b
s_mov_b32 s52, 0x358637bd
s_mov_b32 s53, 0x358637bd
s_barrier
ds_read_b128 v[32:35], v4 offset:0
ds_read_b128 v[36:39], v4 offset:2048
ds_read_b64_tr_b16 v[40:41], v6 offset:0
ds_read_b64_tr_b16 v[42:43], v6 offset:1280
ds_read_b64_tr_b16 v[44:45], v7 offset:32
ds_read_b64_tr_b16 v[46:47], v7 offset:1312
ds_read_b64_tr_b16 v[48:49], v6 offset:64
ds_read_b64_tr_b16 v[50:51], v6 offset:1344
ds_read_b64_tr_b16 v[52:53], v7 offset:96
ds_read_b64_tr_b16 v[54:55], v7 offset:1376
ds_read_b64_tr_b16 v[56:57], v6 offset:128
ds_read_b64_tr_b16 v[58:59], v6 offset:1408
ds_read_b64_tr_b16 v[60:61], v7 offset:160
ds_read_b64_tr_b16 v[62:63], v7 offset:1440
ds_read_b64_tr_b16 v[64:65], v6 offset:192
ds_read_b64_tr_b16 v[66:67], v6 offset:1472
ds_read_b64_tr_b16 v[68:69], v7 offset:224
ds_read_b64_tr_b16 v[70:71], v7 offset:1504
ds_read_b64_tr_b16 v[72:73], v6 offset:256
ds_read_b64_tr_b16 v[74:75], v6 offset:1536
ds_read_b64_tr_b16 v[76:77], v7 offset:288
ds_read_b64_tr_b16 v[78:79], v7 offset:1568
s_cmp_ge_u32 s28, 4
s_cbranch_scc1 L1m1
.p2align 6
L1m0:
s_waitcnt lgkmcnt(0)
v_mfma_f32_16x16x32_bf16 v[128:131], v[32:35], v[40:43], v[128:131]
ds_read_b128 v[80:83], v5 offset:0
ds_read_b128 v[84:87], v5 offset:2048
v_mfma_f32_16x16x32_bf16 v[168:171], v[36:39], v[40:43], v[168:171]
ds_read_b64_tr_b16 v[88:89], v6 offset:10240
v_mfma_f32_16x16x32_bf16 v[132:135], v[32:35], v[44:47], v[132:135]
ds_read_b64_tr_b16 v[90:91], v6 offset:11520
ds_read_b64_tr_b16 v[92:93], v7 offset:10272
v_mfma_f32_16x16x32_bf16 v[172:175], v[36:39], v[44:47], v[172:175]
ds_read_b64_tr_b16 v[94:95], v7 offset:11552
v_mfma_f32_16x16x32_bf16 v[136:139], v[32:35], v[48:51], v[136:139]
ds_read_b64_tr_b16 v[96:97], v6 offset:10304
ds_read_b64_tr_b16 v[98:99], v6 offset:11584
v_mfma_f32_16x16x32_bf16 v[176:179], v[36:39], v[48:51], v[176:179]
ds_read_b64_tr_b16 v[100:101], v7 offset:10336
v_mfma_f32_16x16x32_bf16 v[140:143], v[32:35], v[52:55], v[140:143]
ds_read_b64_tr_b16 v[102:103], v7 offset:11616
ds_read_b64_tr_b16 v[104:105], v6 offset:10368
v_mfma_f32_16x16x32_bf16 v[180:183], v[36:39], v[52:55], v[180:183]
ds_read_b64_tr_b16 v[106:107], v6 offset:11648
v_mfma_f32_16x16x32_bf16 v[144:147], v[32:35], v[56:59], v[144:147]
ds_read_b64_tr_b16 v[108:109], v7 offset:10400
ds_read_b64_tr_b16 v[110:111], v7 offset:11680
v_mfma_f32_16x16x32_bf16 v[184:187], v[36:39], v[56:59], v[184:187]
ds_read_b64_tr_b16 v[112:113], v6 offset:10432
v_mfma_f32_16x16x32_bf16 v[148:151], v[32:35], v[60:63], v[148:151]
ds_read_b64_tr_b16 v[114:115], v6 offset:11712
ds_read_b64_tr_b16 v[116:117], v7 offset:10464
v_mfma_f32_16x16x32_bf16 v[188:191], v[36:39], v[60:63], v[188:191]
ds_read_b64_tr_b16 v[118:119], v7 offset:11744
v_mfma_f32_16x16x32_bf16 v[152:155], v[32:35], v[64:67], v[152:155]
ds_read_b64_tr_b16 v[120:121], v6 offset:10496
ds_read_b64_tr_b16 v[122:123], v6 offset:11776
v_mfma_f32_16x16x32_bf16 v[192:195], v[36:39], v[64:67], v[192:195]
ds_read_b64_tr_b16 v[124:125], v7 offset:10528
v_mfma_f32_16x16x32_bf16 v[156:159], v[32:35], v[68:71], v[156:159]
ds_read_b64_tr_b16 v[126:127], v7 offset:11808
v_mfma_f32_16x16x32_bf16 v[196:199], v[36:39], v[68:71], v[196:199]
v_mfma_f32_16x16x32_bf16 v[160:163], v[32:35], v[72:75], v[160:163]
v_mfma_f32_16x16x32_bf16 v[200:203], v[36:39], v[72:75], v[200:203]
v_mfma_f32_16x16x32_bf16 v[164:167], v[32:35], v[76:79], v[164:167]
v_mfma_f32_16x16x32_bf16 v[204:207], v[36:39], v[76:79], v[204:207]
s_add_u32 s37, s37, 1
s_cmp_ge_u32 s38, 73728
s_cselect_b32 s48, -73728, s49
s_add_u32 s38, s38, s48
v_add_u32 v4, s48, v4
v_add_u32 v5, s48, v5
v_add_u32 v6, s48, v6
v_add_u32 v7, s48, v7
s_waitcnt lgkmcnt(0)
s_barrier
v_mfma_f32_16x16x32_bf16 v[128:131], v[80:83], v[88:91], v[128:131]
ds_read_b128 v[32:35], v4 offset:0
ds_read_b128 v[36:39], v4 offset:2048
v_mfma_f32_16x16x32_bf16 v[168:171], v[84:87], v[88:91], v[168:171]
ds_read_b64_tr_b16 v[40:41], v6 offset:0
v_mfma_f32_16x16x32_bf16 v[132:135], v[80:83], v[92:95], v[132:135]
ds_read_b64_tr_b16 v[42:43], v6 offset:1280
ds_read_b64_tr_b16 v[44:45], v7 offset:32
v_mfma_f32_16x16x32_bf16 v[172:175], v[84:87], v[92:95], v[172:175]
ds_read_b64_tr_b16 v[46:47], v7 offset:1312
v_mfma_f32_16x16x32_bf16 v[136:139], v[80:83], v[96:99], v[136:139]
ds_read_b64_tr_b16 v[48:49], v6 offset:64
ds_read_b64_tr_b16 v[50:51], v6 offset:1344
v_mfma_f32_16x16x32_bf16 v[176:179], v[84:87], v[96:99], v[176:179]
ds_read_b64_tr_b16 v[52:53], v7 offset:96
v_mfma_f32_16x16x32_bf16 v[140:143], v[80:83], v[100:103], v[140:143]
ds_read_b64_tr_b16 v[54:55], v7 offset:1376
ds_read_b64_tr_b16 v[56:57], v6 offset:128
v_mfma_f32_16x16x32_bf16 v[180:183], v[84:87], v[100:103], v[180:183]
ds_read_b64_tr_b16 v[58:59], v6 offset:1408
v_mfma_f32_16x16x32_bf16 v[144:147], v[80:83], v[104:107], v[144:147]
ds_read_b64_tr_b16 v[60:61], v7 offset:160
ds_read_b64_tr_b16 v[62:63], v7 offset:1440
v_mfma_f32_16x16x32_bf16 v[184:187], v[84:87], v[104:107], v[184:187]
ds_read_b64_tr_b16 v[64:65], v6 offset:192
v_mfma_f32_16x16x32_bf16 v[148:151], v[80:83], v[108:111], v[148:151]
ds_read_b64_tr_b16 v[66:67], v6 offset:1472
ds_read_b64_tr_b16 v[68:69], v7 offset:224
v_mfma_f32_16x16x32_bf16 v[188:191], v[84:87], v[108:111], v[188:191]
ds_read_b64_tr_b16 v[70:71], v7 offset:1504
v_mfma_f32_16x16x32_bf16 v[152:155], v[80:83], v[112:115], v[152:155]
ds_read_b64_tr_b16 v[72:73], v6 offset:256
ds_read_b64_tr_b16 v[74:75], v6 offset:1536
v_mfma_f32_16x16x32_bf16 v[192:195], v[84:87], v[112:115], v[192:195]
ds_read_b64_tr_b16 v[76:77], v7 offset:288
v_mfma_f32_16x16x32_bf16 v[156:159], v[80:83], v[116:119], v[156:159]
ds_read_b64_tr_b16 v[78:79], v7 offset:1568
v_mfma_f32_16x16x32_bf16 v[196:199], v[84:87], v[116:119], v[196:199]
v_mfma_f32_16x16x32_bf16 v[160:163], v[80:83], v[120:123], v[160:163]
v_mfma_f32_16x16x32_bf16 v[200:203], v[84:87], v[120:123], v[200:203]
v_mfma_f32_16x16x32_bf16 v[164:167], v[80:83], v[124:127], v[164:167]
v_mfma_f32_16x16x32_bf16 v[204:207], v[84:87], v[124:127], v[204:207]
s_cmp_lt_u32 s37, 10
s_cbranch_scc1 L1m0
s_lshl_b32 s33, s24, 7
s_waitcnt lgkmcnt(0)
v_lshl_add_u32 v8, v1, 4, s33
v_lshlrev_b32 v9, 2, v2
ds_read_b128 v[216:219], v8 offset:37376
ds_read_b128 v[208:211], v8 offset:36864
ds_read_b128 v[220:223], v8 offset:37440
ds_read_b128 v[212:215], v8 offset:36928
ds_read_b32 v32, v9 offset:37888
ds_read_b32 v33, v9 offset:37952
ds_read_b32 v34, v9 offset:38016
ds_read_b32 v35, v9 offset:38080
ds_read_b32 v36, v9 offset:38144
ds_read_b32 v37, v9 offset:38208
ds_read_b32 v38, v9 offset:38272
ds_read_b32 v39, v9 offset:38336
ds_read_b32 v40, v9 offset:38400
ds_read_b32 v41, v9 offset:38464
s_waitcnt lgkmcnt(10)
v_mul_f32 v224, s51, v216
v_mul_f32 v225, s51, v217
v_mul_f32 v226, s51, v218
v_mul_f32 v227, s51, v219
v_mul_f32 v228, s51, v220
v_mul_f32 v229, s51, v221
v_mul_f32 v230, s51, v222
v_mul_f32 v231, s51, v223
s_waitcnt lgkmcnt(0)
Ldk00:
v_pk_fma_f32 v[128:129], v[208:209], v[32:33], v[128:129] op_sel:[0,0,0] op_sel_hi:[1,0,1]
v_pk_mul_f32 v[10:11], v[128:129], v[224:225]
v_pk_fma_f32 v[128:129], v[128:129], v[216:217], s[52:53]
v_exp_f32_e64 v10, v10 clamp
v_exp_f32_e64 v11, v11 clamp
v_max_f32 v128, s52, v128
v_max_f32 v129, s52, v129
v_pk_add_f32 v[128:129], v[128:129], v[10:11]
v_cvt_pk_bf16_f32 v48, v128, v129
v_pk_fma_f32 v[130:131], v[210:211], v[32:33], v[130:131] op_sel:[0,0,0] op_sel_hi:[1,0,1]
v_pk_mul_f32 v[12:13], v[130:131], v[226:227]
v_pk_fma_f32 v[130:131], v[130:131], v[218:219], s[52:53]
v_exp_f32_e64 v12, v12 clamp
v_exp_f32_e64 v13, v13 clamp
v_max_f32 v130, s52, v130
v_max_f32 v131, s52, v131
v_pk_add_f32 v[130:131], v[130:131], v[12:13]
v_cvt_pk_bf16_f32 v49, v130, v131
v_pk_fma_f32 v[168:169], v[212:213], v[32:33], v[168:169] op_sel:[0,0,0] op_sel_hi:[1,0,1]
v_pk_mul_f32 v[10:11], v[168:169], v[228:229]
v_pk_fma_f32 v[168:169], v[168:169], v[220:221], s[52:53]
v_exp_f32_e64 v10, v10 clamp
v_exp_f32_e64 v11, v11 clamp
v_max_f32 v168, s52, v168
v_max_f32 v169, s52, v169
v_pk_add_f32 v[168:169], v[168:169], v[10:11]
v_cvt_pk_bf16_f32 v50, v168, v169
v_pk_fma_f32 v[170:171], v[214:215], v[32:33], v[170:171] op_sel:[0,0,0] op_sel_hi:[1,0,1]
v_pk_mul_f32 v[12:13], v[170:171], v[230:231]
v_pk_fma_f32 v[170:171], v[170:171], v[222:223], s[52:53]
s_cbranch_execz Ldr0
Ldk01:
v_exp_f32_e64 v12, v12 clamp
v_exp_f32_e64 v13, v13 clamp
v_max_f32 v170, s52, v170
v_max_f32 v171, s52, v171
v_pk_add_f32 v[170:171], v[170:171], v[12:13]
v_cvt_pk_bf16_f32 v51, v170, v171
v_pk_fma_f32 v[132:133], v[208:209], v[32:33], v[132:133] op_sel:[0,1,0] op_sel_hi:[1,1,1]
v_pk_mul_f32 v[10:11], v[132:133], v[224:225]
v_pk_fma_f32 v[132:133], v[132:133], v[216:217], s[52:53]
v_exp_f32_e64 v10, v10 clamp
v_exp_f32_e64 v11, v11 clamp
v_max_f32 v132, s52, v132
v_max_f32 v133, s52, v133
v_pk_add_f32 v[132:133], v[132:133], v[10:11]
v_cvt_pk_bf16_f32 v52, v132, v133
v_pk_fma_f32 v[134:135], v[210:211], v[32:33], v[134:135] op_sel:[0,1,0] op_sel_hi:[1,1,1]
v_pk_mul_f32 v[12:13], v[134:135], v[226:227]
v_pk_fma_f32 v[134:135], v[134:135], v[218:219], s[52:53]
v_exp_f32_e64 v12, v12 clamp
v_exp_f32_e64 v13, v13 clamp
v_max_f32 v134, s52, v134
v_max_f32 v135, s52, v135
v_pk_add_f32 v[134:135], v[134:135], v[12:13]
v_cvt_pk_bf16_f32 v53, v134, v135
v_pk_fma_f32 v[172:173], v[212:213], v[32:33], v[172:173] op_sel:[0,1,0] op_sel_hi:[1,1,1]
v_pk_mul_f32 v[10:11], v[172:173], v[228:229]
v_pk_fma_f32 v[172:173], v[172:173], v[220:221], s[52:53]
v_exp_f32_e64 v10, v10 clamp
v_exp_f32_e64 v11, v11 clamp
v_max_f32 v172, s52, v172
s_cbranch_execz Ldr0
Ldk02:
v_max_f32 v173, s52, v173
v_pk_add_f32 v[172:173], v[172:173], v[10:11]
v_cvt_pk_bf16_f32 v54, v172, v173
v_pk_fma_f32 v[174:175], v[214:215], v[32:33], v[174:175] op_sel:[0,1,0] op_sel_hi:[1,1,1]
v_pk_mul_f32 v[12:13], v[174:175], v[230:231]
v_pk_fma_f32 v[174:175], v[174:175], v[222:223], s[52:53]
v_exp_f32_e64 v12, v12 clamp
v_exp_f32_e64 v13, v13 clamp
v_max_f32 v174, s52, v174
v_max_f32 v175, s52, v175
v_pk_add_f32 v[174:175], v[174:175], v[12:13]
v_cvt_pk_bf16_f32 v55, v174, v175
v_pk_fma_f32 v[136:137], v[208:209], v[34:35], v[136:137] op_sel:[0,0,0] op_sel_hi:[1,0,1]
v_pk_mul_f32 v[10:11], v[136:137], v[224:225]
v_pk_fma_f32 v[136:137], v[136:137], v[216:217], s[52:53]
v_exp_f32_e64 v10, v10 clamp
v_exp_f32_e64 v11, v11 clamp
v_max_f32 v136, s52, v136
v_max_f32 v137, s52, v137
v_pk_add_f32 v[136:137], v[136:137], v[10:11]
v_cvt_pk_bf16_f32 v56, v136, v137
v_pk_fma_f32 v[138:139], v[210:211], v[34:35], v[138:139] op_sel:[0,0,0] op_sel_hi:[1,0,1]
v_pk_mul_f32 v[12:13], v[138:139], v[226:227]
v_pk_fma_f32 v[138:139], v[138:139], v[218:219], s[52:53]
v_exp_f32_e64 v12, v12 clamp
v_exp_f32_e64 v13, v13 clamp
v_max_f32 v138, s52, v138
v_max_f32 v139, s52, v139
v_pk_add_f32 v[138:139], v[138:139], v[12:13]
v_cvt_pk_bf16_f32 v57, v138, v139
s_cbranch_execz Ldr0
Ldk03:
v_pk_fma_f32 v[176:177], v[212:213], v[34:35], v[176:177] op_sel:[0,0,0] op_sel_hi:[1,0,1]
v_pk_mul_f32 v[10:11], v[176:177], v[228:229]
v_pk_fma_f32 v[176:177], v[176:177], v[220:221], s[52:53]
v_exp_f32_e64 v10, v10 clamp
v_exp_f32_e64 v11, v11 clamp
v_max_f32 v176, s52, v176
v_max_f32 v177, s52, v177
v_pk_add_f32 v[176:177], v[176:177], v[10:11]
v_cvt_pk_bf16_f32 v58, v176, v177
v_pk_fma_f32 v[178:179], v[214:215], v[34:35], v[178:179] op_sel:[0,0,0] op_sel_hi:[1,0,1]
v_pk_mul_f32 v[12:13], v[178:179], v[230:231]
v_pk_fma_f32 v[178:179], v[178:179], v[222:223], s[52:53]
v_exp_f32_e64 v12, v12 clamp
v_exp_f32_e64 v13, v13 clamp
v_max_f32 v178, s52, v178
v_max_f32 v179, s52, v179
v_pk_add_f32 v[178:179], v[178:179], v[12:13]
v_cvt_pk_bf16_f32 v59, v178, v179
v_pk_fma_f32 v[140:141], v[208:209], v[34:35], v[140:141] op_sel:[0,1,0] op_sel_hi:[1,1,1]
v_pk_mul_f32 v[10:11], v[140:141], v[224:225]
v_pk_fma_f32 v[140:141], v[140:141], v[216:217], s[52:53]
v_exp_f32_e64 v10, v10 clamp
v_exp_f32_e64 v11, v11 clamp
v_max_f32 v140, s52, v140
v_max_f32 v141, s52, v141
v_pk_add_f32 v[140:141], v[140:141], v[10:11]
v_cvt_pk_bf16_f32 v60, v140, v141
v_pk_fma_f32 v[142:143], v[210:211], v[34:35], v[142:143] op_sel:[0,1,0] op_sel_hi:[1,1,1]
v_pk_mul_f32 v[12:13], v[142:143], v[226:227]
v_pk_fma_f32 v[142:143], v[142:143], v[218:219], s[52:53]
s_cbranch_execz Ldr0
Ldk10:
v_exp_f32_e64 v12, v12 clamp
v_exp_f32_e64 v13, v13 clamp
v_max_f32 v142, s52, v142
v_max_f32 v143, s52, v143
v_pk_add_f32 v[142:143], v[142:143], v[12:13]
v_cvt_pk_bf16_f32 v61, v142, v143
v_pk_fma_f32 v[180:181], v[212:213], v[34:35], v[180:181] op_sel:[0,1,0] op_sel_hi:[1,1,1]
v_pk_mul_f32 v[10:11], v[180:181], v[228:229]
v_pk_fma_f32 v[180:181], v[180:181], v[220:221], s[52:53]
v_exp_f32_e64 v10, v10 clamp
v_exp_f32_e64 v11, v11 clamp
v_max_f32 v180, s52, v180
v_max_f32 v181, s52, v181
v_pk_add_f32 v[180:181], v[180:181], v[10:11]
v_cvt_pk_bf16_f32 v62, v180, v181
v_pk_fma_f32 v[182:183], v[214:215], v[34:35], v[182:183] op_sel:[0,1,0] op_sel_hi:[1,1,1]
v_pk_mul_f32 v[12:13], v[182:183], v[230:231]
v_pk_fma_f32 v[182:183], v[182:183], v[222:223], s[52:53]
v_exp_f32_e64 v12, v12 clamp
v_exp_f32_e64 v13, v13 clamp
v_max_f32 v182, s52, v182
v_max_f32 v183, s52, v183
v_pk_add_f32 v[182:183], v[182:183], v[12:13]
v_cvt_pk_bf16_f32 v63, v182, v183
v_pk_fma_f32 v[144:145], v[208:209], v[36:37], v[144:145] op_sel:[0,0,0] op_sel_hi:[1,0,1]
v_pk_mul_f32 v[10:11], v[144:145], v[224:225]
v_pk_fma_f32 v[144:145], v[144:145], v[216:217], s[52:53]
v_exp_f32_e64 v10, v10 clamp
v_exp_f32_e64 v11, v11 clamp
v_max_f32 v144, s52, v144
s_cbranch_execz Ldr1
Ldk11:
v_max_f32 v145, s52, v145
v_pk_add_f32 v[144:145], v[144:145], v[10:11]
v_cvt_pk_bf16_f32 v64, v144, v145
v_pk_fma_f32 v[146:147], v[210:211], v[36:37], v[146:147] op_sel:[0,0,0] op_sel_hi:[1,0,1]
v_pk_mul_f32 v[12:13], v[146:147], v[226:227]
v_pk_fma_f32 v[146:147], v[146:147], v[218:219], s[52:53]
v_exp_f32_e64 v12, v12 clamp
v_exp_f32_e64 v13, v13 clamp
v_max_f32 v146, s52, v146
v_max_f32 v147, s52, v147
v_pk_add_f32 v[146:147], v[146:147], v[12:13]
v_cvt_pk_bf16_f32 v65, v146, v147
v_pk_fma_f32 v[184:185], v[212:213], v[36:37], v[184:185] op_sel:[0,0,0] op_sel_hi:[1,0,1]
v_pk_mul_f32 v[10:11], v[184:185], v[228:229]
v_pk_fma_f32 v[184:185], v[184:185], v[220:221], s[52:53]
v_exp_f32_e64 v10, v10 clamp
v_exp_f32_e64 v11, v11 clamp
v_max_f32 v184, s52, v184
v_max_f32 v185, s52, v185
v_pk_add_f32 v[184:185], v[184:185], v[10:11]
v_cvt_pk_bf16_f32 v66, v184, v185
v_pk_fma_f32 v[186:187], v[214:215], v[36:37], v[186:187] op_sel:[0,0,0] op_sel_hi:[1,0,1]
v_pk_mul_f32 v[12:13], v[186:187], v[230:231]
v_pk_fma_f32 v[186:187], v[186:187], v[222:223], s[52:53]
v_exp_f32_e64 v12, v12 clamp
v_exp_f32_e64 v13, v13 clamp
v_max_f32 v186, s52, v186
v_max_f32 v187, s52, v187
v_pk_add_f32 v[186:187], v[186:187], v[12:13]
v_cvt_pk_bf16_f32 v67, v186, v187
s_cbranch_execz Ldr1
Ldk12:
v_pk_fma_f32 v[148:149], v[208:209], v[36:37], v[148:149] op_sel:[0,1,0] op_sel_hi:[1,1,1]
v_pk_mul_f32 v[148:149], v[148:149], v[216:217]
v_cvt_pk_bf16_f32 v68, v148, v149
v_pk_fma_f32 v[150:151], v[210:211], v[36:37], v[150:151] op_sel:[0,1,0] op_sel_hi:[1,1,1]
v_pk_mul_f32 v[150:151], v[150:151], v[218:219]
v_cvt_pk_bf16_f32 v69, v150, v151
v_pk_fma_f32 v[188:189], v[212:213], v[36:37], v[188:189] op_sel:[0,1,0] op_sel_hi:[1,1,1]
v_pk_mul_f32 v[188:189], v[188:189], v[220:221]
v_cvt_pk_bf16_f32 v70, v188, v189
v_pk_fma_f32 v[190:191], v[214:215], v[36:37], v[190:191] op_sel:[0,1,0] op_sel_hi:[1,1,1]
v_pk_mul_f32 v[190:191], v[190:191], v[222:223]
v_cvt_pk_bf16_f32 v71, v190, v191
v_pk_fma_f32 v[152:153], v[208:209], v[38:39], v[152:153] op_sel:[0,0,0] op_sel_hi:[1,0,1]
v_pk_mul_f32 v[152:153], v[152:153], v[216:217]
v_cvt_pk_bf16_f32 v72, v152, v153
v_pk_fma_f32 v[154:155], v[210:211], v[38:39], v[154:155] op_sel:[0,0,0] op_sel_hi:[1,0,1]
v_pk_mul_f32 v[154:155], v[154:155], v[218:219]
v_cvt_pk_bf16_f32 v73, v154, v155
v_pk_fma_f32 v[192:193], v[212:213], v[38:39], v[192:193] op_sel:[0,0,0] op_sel_hi:[1,0,1]
v_pk_mul_f32 v[192:193], v[192:193], v[220:221]
v_cvt_pk_bf16_f32 v74, v192, v193
v_pk_fma_f32 v[194:195], v[214:215], v[38:39], v[194:195] op_sel:[0,0,0] op_sel_hi:[1,0,1]
v_pk_mul_f32 v[194:195], v[194:195], v[222:223]
v_cvt_pk_bf16_f32 v75, v194, v195
v_pk_fma_f32 v[156:157], v[208:209], v[38:39], v[156:157] op_sel:[0,1,0] op_sel_hi:[1,1,1]
v_pk_mul_f32 v[156:157], v[156:157], v[216:217]
v_cvt_pk_bf16_f32 v76, v156, v157
v_pk_fma_f32 v[158:159], v[210:211], v[38:39], v[158:159] op_sel:[0,1,0] op_sel_hi:[1,1,1]
v_pk_mul_f32 v[158:159], v[158:159], v[218:219]
v_cvt_pk_bf16_f32 v77, v158, v159
s_cbranch_execz Ldr1
Ldk13:
v_pk_fma_f32 v[196:197], v[212:213], v[38:39], v[196:197] op_sel:[0,1,0] op_sel_hi:[1,1,1]
v_pk_mul_f32 v[196:197], v[196:197], v[220:221]
v_cvt_pk_bf16_f32 v78, v196, v197
v_pk_fma_f32 v[198:199], v[214:215], v[38:39], v[198:199] op_sel:[0,1,0] op_sel_hi:[1,1,1]
v_pk_mul_f32 v[198:199], v[198:199], v[222:223]
v_cvt_pk_bf16_f32 v79, v198, v199
v_pk_fma_f32 v[160:161], v[208:209], v[40:41], v[160:161] op_sel:[0,0,0] op_sel_hi:[1,0,1]
v_pk_mul_f32 v[160:161], v[160:161], v[216:217]
v_cvt_pk_bf16_f32 v80, v160, v161
v_pk_fma_f32 v[162:163], v[210:211], v[40:41], v[162:163] op_sel:[0,0,0] op_sel_hi:[1,0,1]
v_pk_mul_f32 v[162:163], v[162:163], v[218:219]
v_cvt_pk_bf16_f32 v81, v162, v163
v_pk_fma_f32 v[200:201], v[212:213], v[40:41], v[200:201] op_sel:[0,0,0] op_sel_hi:[1,0,1]
v_pk_mul_f32 v[200:201], v[200:201], v[220:221]
v_cvt_pk_bf16_f32 v82, v200, v201
v_pk_fma_f32 v[202:203], v[214:215], v[40:41], v[202:203] op_sel:[0,0,0] op_sel_hi:[1,0,1]
v_pk_mul_f32 v[202:203], v[202:203], v[222:223]
v_cvt_pk_bf16_f32 v83, v202, v203
v_pk_fma_f32 v[164:165], v[208:209], v[40:41], v[164:165] op_sel:[0,1,0] op_sel_hi:[1,1,1]
v_pk_mul_f32 v[164:165], v[164:165], v[216:217]
v_cvt_pk_bf16_f32 v84, v164, v165
v_pk_fma_f32 v[166:167], v[210:211], v[40:41], v[166:167] op_sel:[0,1,0] op_sel_hi:[1,1,1]
v_pk_mul_f32 v[166:167], v[166:167], v[218:219]
v_cvt_pk_bf16_f32 v85, v166, v167
v_pk_fma_f32 v[204:205], v[212:213], v[40:41], v[204:205] op_sel:[0,1,0] op_sel_hi:[1,1,1]
v_pk_mul_f32 v[204:205], v[204:205], v[220:221]
v_cvt_pk_bf16_f32 v86, v204, v205
v_pk_fma_f32 v[206:207], v[214:215], v[40:41], v[206:207] op_sel:[0,1,0] op_sel_hi:[1,1,1]
v_pk_mul_f32 v[206:207], v[206:207], v[222:223]
v_cvt_pk_bf16_f32 v87, v206, v207
s_cbranch_execz Ldr1
v_mfma_f32_16x16x32_bf16 v[128:131], v[48:51], v[68:71], 0
v_mfma_f32_16x16x32_bf16 v[132:135], v[48:51], v[72:75], 0
v_mfma_f32_16x16x32_bf16 v[136:139], v[52:55], v[68:71], 0
v_mfma_f32_16x16x32_bf16 v[140:143], v[52:55], v[72:75], 0
v_mfma_f32_16x16x32_bf16 v[144:147], v[52:55], v[76:79], 0
v_mfma_f32_16x16x32_bf16 v[148:151], v[56:59], v[72:75], 0
s_nop 2
ds_write_b128 v236, v[128:131]
v_mfma_f32_16x16x32_bf16 v[152:155], v[56:59], v[76:79], 0
ds_write_b128 v237, v[132:135]
v_mfma_f32_16x16x32_bf16 v[156:159], v[56:59], v[80:83], 0
ds_write_b128 v238, v[136:139]
v_mfma_f32_16x16x32_bf16 v[160:163], v[60:63], v[76:79], 0
ds_write_b128 v239, v[140:143]
v_mfma_f32_16x16x32_bf16 v[164:167], v[60:63], v[80:83], 0
ds_write_b128 v240, v[144:147]
v_mfma_f32_16x16x32_bf16 v[168:171], v[60:63], v[84:87], 0
ds_write_b128 v241, v[148:151]
v_mfma_f32_16x16x32_bf16 v[172:175], v[64:67], v[80:83], 0
ds_write_b128 v242, v[152:155]
v_mfma_f32_16x16x32_bf16 v[176:179], v[64:67], v[84:87], 0
ds_write_b128 v243, v[156:159]
v_mfma_f32_16x16x32_bf16 v[180:183], v[48:51], v[28:31], 0
ds_write_b128 v244, v[160:163]
v_mfma_f32_16x16x32_bf16 v[184:187], v[52:55], v[28:31], 0
ds_write_b128 v245, v[164:167]
v_mfma_f32_16x16x32_bf16 v[188:191], v[56:59], v[28:31], 0
ds_write_b128 v246, v[168:171]
v_mfma_f32_16x16x32_bf16 v[192:195], v[60:63], v[28:31], 0
ds_write_b128 v247, v[172:175]
v_mfma_f32_16x16x32_bf16 v[196:199], v[64:67], v[28:31], 0
ds_write_b128 v248, v[176:179]
ds_write_b128 v249, v[180:183]
ds_write_b128 v250, v[184:187]
s_nop 0
ds_write_b128 v251, v[188:191]
s_nop 0
ds_write_b128 v252, v[192:195]
s_nop 0
ds_write_b128 v253, v[196:199]
s_lshl_b32 s33, s24, 8
v_lshl_add_u32 v8, v0, 2, s33
v_add_u32 v10, 4096, v8
s_waitcnt lgkmcnt(0)
s_barrier
ds_read2st64_b32 v[32:33], v8 offset0:0 offset1:32
ds_read2st64_b32 v[34:35], v8 offset0:64 offset1:96
ds_read2st64_b32 v[36:37], v8 offset0:4 offset1:36
ds_read2st64_b32 v[38:39], v8 offset0:68 offset1:100
ds_read2st64_b32 v[40:41], v8 offset0:8 offset1:40
ds_read2st64_b32 v[42:43], v8 offset0:72 offset1:104
ds_read2st64_b32 v[44:45], v8 offset0:12 offset1:44
ds_read2st64_b32 v[46:47], v8 offset0:76 offset1:108
ds_read2st64_b32 v[48:49], v8 offset0:16 offset1:48
ds_read2st64_b32 v[50:51], v8 offset0:80 offset1:112
ds_read2st64_b32 v[52:53], v8 offset0:20 offset1:52
ds_read2st64_b32 v[54:55], v8 offset0:84 offset1:116
ds_read2st64_b32 v[56:57], v8 offset0:24 offset1:56
ds_read2st64_b32 v[58:59], v8 offset0:88 offset1:120
s_waitcnt lgkmcnt(12)
v_pk_add_f32 v[32:33], v[32:33], v[34:35]
v_add_f32 v32, v32, v33
buffer_atomic_add_f32 v32, v8, s[44:47], 0 offen offset:0
s_waitcnt lgkmcnt(10)
v_pk_add_f32 v[36:37], v[36:37], v[38:39]
v_add_f32 v36, v36, v37
buffer_atomic_add_f32 v36, v8, s[44:47], 0 offen offset:1024
s_waitcnt lgkmcnt(8)
v_pk_add_f32 v[40:41], v[40:41], v[42:43]
v_add_f32 v40, v40, v41
buffer_atomic_add_f32 v40, v8, s[44:47], 0 offen offset:2048
s_waitcnt lgkmcnt(6)
v_pk_add_f32 v[44:45], v[44:45], v[46:47]
v_add_f32 v44, v44, v45
buffer_atomic_add_f32 v44, v8, s[44:47], 0 offen offset:3072
s_waitcnt lgkmcnt(4)
v_pk_add_f32 v[48:49], v[48:49], v[50:51]
v_add_f32 v48, v48, v49
buffer_atomic_add_f32 v48, v10, s[44:47], 0 offen offset:0
s_waitcnt lgkmcnt(2)
v_pk_add_f32 v[52:53], v[52:53], v[54:55]
v_add_f32 v52, v52, v53
buffer_atomic_add_f32 v52, v10, s[44:47], 0 offen offset:1024
s_waitcnt lgkmcnt(0)
v_pk_add_f32 v[56:57], v[56:57], v[58:59]
v_add_f32 v56, v56, v57
buffer_atomic_add_f32 v56, v10, s[44:47], 0 offen offset:2048
s_branch LC2
.p2align 6
L1m1:
s_waitcnt lgkmcnt(0)
v_mfma_f32_16x16x32_bf16 v[128:131], v[40:43], v[32:35], v[128:131]
ds_read_b128 v[80:83], v5 offset:0
ds_read_b128 v[84:87], v5 offset:2048
v_mfma_f32_16x16x32_bf16 v[168:171], v[40:43], v[36:39], v[168:171]
ds_read_b64_tr_b16 v[88:89], v6 offset:10240
v_mfma_f32_16x16x32_bf16 v[132:135], v[44:47], v[32:35], v[132:135]
ds_read_b64_tr_b16 v[90:91], v6 offset:11520
ds_read_b64_tr_b16 v[92:93], v7 offset:10272
v_mfma_f32_16x16x32_bf16 v[172:175], v[44:47], v[36:39], v[172:175]
ds_read_b64_tr_b16 v[94:95], v7 offset:11552
v_mfma_f32_16x16x32_bf16 v[136:139], v[48:51], v[32:35], v[136:139]
ds_read_b64_tr_b16 v[96:97], v6 offset:10304
ds_read_b64_tr_b16 v[98:99], v6 offset:11584
v_mfma_f32_16x16x32_bf16 v[176:179], v[48:51], v[36:39], v[176:179]
ds_read_b64_tr_b16 v[100:101], v7 offset:10336
v_mfma_f32_16x16x32_bf16 v[140:143], v[52:55], v[32:35], v[140:143]
ds_read_b64_tr_b16 v[102:103], v7 offset:11616
ds_read_b64_tr_b16 v[104:105], v6 offset:10368
v_mfma_f32_16x16x32_bf16 v[180:183], v[52:55], v[36:39], v[180:183]
ds_read_b64_tr_b16 v[106:107], v6 offset:11648
v_mfma_f32_16x16x32_bf16 v[144:147], v[56:59], v[32:35], v[144:147]
ds_read_b64_tr_b16 v[108:109], v7 offset:10400
ds_read_b64_tr_b16 v[110:111], v7 offset:11680
v_mfma_f32_16x16x32_bf16 v[184:187], v[56:59], v[36:39], v[184:187]
ds_read_b64_tr_b16 v[112:113], v6 offset:10432
v_mfma_f32_16x16x32_bf16 v[148:151], v[60:63], v[32:35], v[148:151]
ds_read_b64_tr_b16 v[114:115], v6 offset:11712
ds_read_b64_tr_b16 v[116:117], v7 offset:10464
v_mfma_f32_16x16x32_bf16 v[188:191], v[60:63], v[36:39], v[188:191]
ds_read_b64_tr_b16 v[118:119], v7 offset:11744
v_mfma_f32_16x16x32_bf16 v[152:155], v[64:67], v[32:35], v[152:155]
ds_read_b64_tr_b16 v[120:121], v6 offset:10496
ds_read_b64_tr_b16 v[122:123], v6 offset:11776
v_mfma_f32_16x16x32_bf16 v[192:195], v[64:67], v[36:39], v[192:195]
ds_read_b64_tr_b16 v[124:125], v7 offset:10528
v_mfma_f32_16x16x32_bf16 v[156:159], v[68:71], v[32:35], v[156:159]
ds_read_b64_tr_b16 v[126:127], v7 offset:11808
v_mfma_f32_16x16x32_bf16 v[196:199], v[68:71], v[36:39], v[196:199]
v_mfma_f32_16x16x32_bf16 v[160:163], v[72:75], v[32:35], v[160:163]
v_mfma_f32_16x16x32_bf16 v[200:203], v[72:75], v[36:39], v[200:203]
v_mfma_f32_16x16x32_bf16 v[164:167], v[76:79], v[32:35], v[164:167]
v_mfma_f32_16x16x32_bf16 v[204:207], v[76:79], v[36:39], v[204:207]
s_add_u32 s37, s37, 1
s_cmp_ge_u32 s38, 73728
s_cselect_b32 s48, -73728, s49
s_add_u32 s38, s38, s48
v_add_u32 v4, s48, v4
v_add_u32 v5, s48, v5
v_add_u32 v6, s48, v6
v_add_u32 v7, s48, v7
s_waitcnt lgkmcnt(0)
s_barrier
v_mfma_f32_16x16x32_bf16 v[128:131], v[88:91], v[80:83], v[128:131]
ds_read_b128 v[32:35], v4 offset:0
ds_read_b128 v[36:39], v4 offset:2048
v_mfma_f32_16x16x32_bf16 v[168:171], v[88:91], v[84:87], v[168:171]
ds_read_b64_tr_b16 v[40:41], v6 offset:0
v_mfma_f32_16x16x32_bf16 v[132:135], v[92:95], v[80:83], v[132:135]
ds_read_b64_tr_b16 v[42:43], v6 offset:1280
ds_read_b64_tr_b16 v[44:45], v7 offset:32
v_mfma_f32_16x16x32_bf16 v[172:175], v[92:95], v[84:87], v[172:175]
ds_read_b64_tr_b16 v[46:47], v7 offset:1312
v_mfma_f32_16x16x32_bf16 v[136:139], v[96:99], v[80:83], v[136:139]
ds_read_b64_tr_b16 v[48:49], v6 offset:64
ds_read_b64_tr_b16 v[50:51], v6 offset:1344
v_mfma_f32_16x16x32_bf16 v[176:179], v[96:99], v[84:87], v[176:179]
ds_read_b64_tr_b16 v[52:53], v7 offset:96
v_mfma_f32_16x16x32_bf16 v[140:143], v[100:103], v[80:83], v[140:143]
ds_read_b64_tr_b16 v[54:55], v7 offset:1376
ds_read_b64_tr_b16 v[56:57], v6 offset:128
v_mfma_f32_16x16x32_bf16 v[180:183], v[100:103], v[84:87], v[180:183]
ds_read_b64_tr_b16 v[58:59], v6 offset:1408
v_mfma_f32_16x16x32_bf16 v[144:147], v[104:107], v[80:83], v[144:147]
ds_read_b64_tr_b16 v[60:61], v7 offset:160
ds_read_b64_tr_b16 v[62:63], v7 offset:1440
v_mfma_f32_16x16x32_bf16 v[184:187], v[104:107], v[84:87], v[184:187]
ds_read_b64_tr_b16 v[64:65], v6 offset:192
v_mfma_f32_16x16x32_bf16 v[148:151], v[108:111], v[80:83], v[148:151]
ds_read_b64_tr_b16 v[66:67], v6 offset:1472
ds_read_b64_tr_b16 v[68:69], v7 offset:224
v_mfma_f32_16x16x32_bf16 v[188:191], v[108:111], v[84:87], v[188:191]
ds_read_b64_tr_b16 v[70:71], v7 offset:1504
v_mfma_f32_16x16x32_bf16 v[152:155], v[112:115], v[80:83], v[152:155]
ds_read_b64_tr_b16 v[72:73], v6 offset:256
ds_read_b64_tr_b16 v[74:75], v6 offset:1536
v_mfma_f32_16x16x32_bf16 v[192:195], v[112:115], v[84:87], v[192:195]
ds_read_b64_tr_b16 v[76:77], v7 offset:288
v_mfma_f32_16x16x32_bf16 v[156:159], v[116:119], v[80:83], v[156:159]
ds_read_b64_tr_b16 v[78:79], v7 offset:1568
v_mfma_f32_16x16x32_bf16 v[196:199], v[116:119], v[84:87], v[196:199]
v_mfma_f32_16x16x32_bf16 v[160:163], v[120:123], v[80:83], v[160:163]
v_mfma_f32_16x16x32_bf16 v[200:203], v[120:123], v[84:87], v[200:203]
v_mfma_f32_16x16x32_bf16 v[164:167], v[124:127], v[80:83], v[164:167]
v_mfma_f32_16x16x32_bf16 v[204:207], v[124:127], v[84:87], v[204:207]
s_cmp_lt_u32 s37, 10
s_cbranch_scc1 L1m1
s_lshl_b32 s33, s24, 7
s_waitcnt lgkmcnt(0)
v_lshl_add_u32 v8, v2, 2, s33
v_lshlrev_b32 v9, 4, v1
ds_read_b32 v216, v8 offset:37376
ds_read_b32 v208, v8 offset:36864
ds_read_b32 v220, v8 offset:37440
ds_read_b32 v212, v8 offset:36928
ds_read_b128 v[32:35], v9 offset:37888
ds_read_b128 v[36:39], v9 offset:37952
ds_read_b128 v[40:43], v9 offset:38016
ds_read_b128 v[44:47], v9 offset:38080
ds_read_b128 v[48:51], v9 offset:38144
ds_read_b128 v[52:55], v9 offset:38208
ds_read_b128 v[56:59], v9 offset:38272
ds_read_b128 v[60:63], v9 offset:38336
ds_read_b128 v[64:67], v9 offset:38400
ds_read_b128 v[68:71], v9 offset:38464
s_lshl2_add_u32 s33, s29, s24
s_mul_i32 s33, s33, 40
s_mul_i32 s34, s31, 5
s_add_u32 s33, s33, s34
s_lshl_b32 s33, s33, 10
s_waitcnt lgkmcnt(10)
v_mul_f32 v224, s51, v216
v_mul_f32 v228, s51, v220
s_waitcnt lgkmcnt(0)
Ldq00:
v_pk_fma_f32 v[128:129], v[208:209], v[32:33], v[128:129] op_sel_hi:[0,1,1]
v_pk_mul_f32 v[10:11], v[128:129], v[224:225] op_sel_hi:[1,0]
v_pk_fma_f32 v[128:129], v[128:129], v[216:217], s[52:53] op_sel_hi:[1,0,1]
v_exp_f32_e64 v10, v10 clamp
v_exp_f32_e64 v11, v11 clamp
v_max_f32 v128, s52, v128
v_max_f32 v129, s52, v129
v_pk_add_f32 v[128:129], v[128:129], v[10:11]
v_cvt_pk_bf16_f32 v80, v128, v129
v_pk_fma_f32 v[130:131], v[208:209], v[34:35], v[130:131] op_sel_hi:[0,1,1]
v_pk_mul_f32 v[12:13], v[130:131], v[224:225] op_sel_hi:[1,0]
v_pk_fma_f32 v[130:131], v[130:131], v[216:217], s[52:53] op_sel_hi:[1,0,1]
v_exp_f32_e64 v12, v12 clamp
v_exp_f32_e64 v13, v13 clamp
v_max_f32 v130, s52, v130
v_max_f32 v131, s52, v131
v_pk_add_f32 v[130:131], v[130:131], v[12:13]
v_cvt_pk_bf16_f32 v81, v130, v131
v_pk_fma_f32 v[132:133], v[208:209], v[36:37], v[132:133] op_sel_hi:[0,1,1]
v_pk_mul_f32 v[10:11], v[132:133], v[224:225] op_sel_hi:[1,0]
v_pk_fma_f32 v[132:133], v[132:133], v[216:217], s[52:53] op_sel_hi:[1,0,1]
v_exp_f32_e64 v10, v10 clamp
v_exp_f32_e64 v11, v11 clamp
v_max_f32 v132, s52, v132
v_max_f32 v133, s52, v133
v_pk_add_f32 v[132:133], v[132:133], v[10:11]
v_cvt_pk_bf16_f32 v82, v132, v133
v_pk_fma_f32 v[134:135], v[208:209], v[38:39], v[134:135] op_sel_hi:[0,1,1]
v_pk_mul_f32 v[12:13], v[134:135], v[224:225] op_sel_hi:[1,0]
v_pk_fma_f32 v[134:135], v[134:135], v[216:217], s[52:53] op_sel_hi:[1,0,1]
v_exp_f32_e64 v12, v12 clamp
v_exp_f32_e64 v13, v13 clamp
v_max_f32 v134, s52, v134
v_max_f32 v135, s52, v135
v_pk_add_f32 v[134:135], v[134:135], v[12:13]
v_cvt_pk_bf16_f32 v83, v134, v135
s_cbranch_execz Lqs01
s_add_u32 s34, s33, 0
buffer_store_dwordx4 v[80:83], v3, s[40:43], s34 offen sc1
Lqs01:
v_pk_fma_f32 v[136:137], v[208:209], v[40:41], v[136:137] op_sel_hi:[0,1,1]
v_pk_mul_f32 v[10:11], v[136:137], v[224:225] op_sel_hi:[1,0]
v_pk_fma_f32 v[136:137], v[136:137], v[216:217], s[52:53] op_sel_hi:[1,0,1]
v_exp_f32_e64 v10, v10 clamp
v_exp_f32_e64 v11, v11 clamp
v_max_f32 v136, s52, v136
v_max_f32 v137, s52, v137
v_pk_add_f32 v[136:137], v[136:137], v[10:11]
v_cvt_pk_bf16_f32 v84, v136, v137
v_pk_fma_f32 v[138:139], v[208:209], v[42:43], v[138:139] op_sel_hi:[0,1,1]
s_cbranch_execz Ldr0
Ldq01:
v_pk_mul_f32 v[12:13], v[138:139], v[224:225] op_sel_hi:[1,0]
v_pk_fma_f32 v[138:139], v[138:139], v[216:217], s[52:53] op_sel_hi:[1,0,1]
v_exp_f32_e64 v12, v12 clamp
v_exp_f32_e64 v13, v13 clamp
v_max_f32 v138, s52, v138
v_max_f32 v139, s52, v139
v_pk_add_f32 v[138:139], v[138:139], v[12:13]
v_cvt_pk_bf16_f32 v85, v138, v139
v_pk_fma_f32 v[140:141], v[208:209], v[44:45], v[140:141] op_sel_hi:[0,1,1]
v_pk_mul_f32 v[10:11], v[140:141], v[224:225] op_sel_hi:[1,0]
v_pk_fma_f32 v[140:141], v[140:141], v[216:217], s[52:53] op_sel_hi:[1,0,1]
v_exp_f32_e64 v10, v10 clamp
v_exp_f32_e64 v11, v11 clamp
v_max_f32 v140, s52, v140
v_max_f32 v141, s52, v141
v_pk_add_f32 v[140:141], v[140:141], v[10:11]
v_cvt_pk_bf16_f32 v86, v140, v141
v_pk_fma_f32 v[142:143], v[208:209], v[46:47], v[142:143] op_sel_hi:[0,1,1]
v_pk_mul_f32 v[12:13], v[142:143], v[224:225] op_sel_hi:[1,0]
v_pk_fma_f32 v[142:143], v[142:143], v[216:217], s[52:53] op_sel_hi:[1,0,1]
v_exp_f32_e64 v12, v12 clamp
v_exp_f32_e64 v13, v13 clamp
v_max_f32 v142, s52, v142
v_max_f32 v143, s52, v143
v_pk_add_f32 v[142:143], v[142:143], v[12:13]
v_cvt_pk_bf16_f32 v87, v142, v143
s_cbranch_execz Lqs03
s_add_u32 s34, s33, 1024
buffer_store_dwordx4 v[84:87], v3, s[40:43], s34 offen sc1
Lqs03:
v_pk_fma_f32 v[144:145], v[208:209], v[48:49], v[144:145] op_sel_hi:[0,1,1]
v_pk_mul_f32 v[10:11], v[144:145], v[224:225] op_sel_hi:[1,0]
v_pk_fma_f32 v[144:145], v[144:145], v[216:217], s[52:53] op_sel_hi:[1,0,1]
v_exp_f32_e64 v10, v10 clamp
v_exp_f32_e64 v11, v11 clamp
v_max_f32 v144, s52, v144
v_max_f32 v145, s52, v145
v_pk_add_f32 v[144:145], v[144:145], v[10:11]
v_cvt_pk_bf16_f32 v80, v144, v145
v_pk_fma_f32 v[146:147], v[208:209], v[50:51], v[146:147] op_sel_hi:[0,1,1]
v_pk_mul_f32 v[12:13], v[146:147], v[224:225] op_sel_hi:[1,0]
v_pk_fma_f32 v[146:147], v[146:147], v[216:217], s[52:53] op_sel_hi:[1,0,1]
v_exp_f32_e64 v12, v12 clamp
v_exp_f32_e64 v13, v13 clamp
v_max_f32 v146, s52, v146
v_max_f32 v147, s52, v147
v_pk_add_f32 v[146:147], v[146:147], v[12:13]
v_cvt_pk_bf16_f32 v81, v146, v147
v_pk_fma_f32 v[148:149], v[208:209], v[52:53], v[148:149] op_sel_hi:[0,1,1]
v_pk_mul_f32 v[10:11], v[148:149], v[224:225] op_sel_hi:[1,0]
s_cbranch_execz Ldr0
Ldq02:
v_pk_fma_f32 v[148:149], v[148:149], v[216:217], s[52:53] op_sel_hi:[1,0,1]
v_exp_f32_e64 v10, v10 clamp
v_exp_f32_e64 v11, v11 clamp
v_max_f32 v148, s52, v148
v_max_f32 v149, s52, v149
v_pk_add_f32 v[148:149], v[148:149], v[10:11]
v_cvt_pk_bf16_f32 v82, v148, v149
v_pk_fma_f32 v[150:151], v[208:209], v[54:55], v[150:151] op_sel_hi:[0,1,1]
v_pk_mul_f32 v[12:13], v[150:151], v[224:225] op_sel_hi:[1,0]
v_pk_fma_f32 v[150:151], v[150:151], v[216:217], s[52:53] op_sel_hi:[1,0,1]
v_exp_f32_e64 v12, v12 clamp
v_exp_f32_e64 v13, v13 clamp
v_max_f32 v150, s52, v150
v_max_f32 v151, s52, v151
v_pk_add_f32 v[150:151], v[150:151], v[12:13]
v_cvt_pk_bf16_f32 v83, v150, v151
s_cbranch_execz Lqs05
s_add_u32 s34, s33, 2048
buffer_store_dwordx4 v[80:83], v3, s[40:43], s34 offen sc1
Lqs05:
v_pk_fma_f32 v[152:153], v[208:209], v[56:57], v[152:153] op_sel_hi:[0,1,1]
v_pk_mul_f32 v[10:11], v[152:153], v[224:225] op_sel_hi:[1,0]
v_pk_fma_f32 v[152:153], v[152:153], v[216:217], s[52:53] op_sel_hi:[1,0,1]
v_exp_f32_e64 v10, v10 clamp
v_exp_f32_e64 v11, v11 clamp
v_max_f32 v152, s52, v152
v_max_f32 v153, s52, v153
v_pk_add_f32 v[152:153], v[152:153], v[10:11]
v_cvt_pk_bf16_f32 v84, v152, v153
v_pk_fma_f32 v[154:155], v[208:209], v[58:59], v[154:155] op_sel_hi:[0,1,1]
v_pk_mul_f32 v[12:13], v[154:155], v[224:225] op_sel_hi:[1,0]
v_pk_fma_f32 v[154:155], v[154:155], v[216:217], s[52:53] op_sel_hi:[1,0,1]
v_exp_f32_e64 v12, v12 clamp
v_exp_f32_e64 v13, v13 clamp
v_max_f32 v154, s52, v154
v_max_f32 v155, s52, v155
v_pk_add_f32 v[154:155], v[154:155], v[12:13]
v_cvt_pk_bf16_f32 v85, v154, v155
v_pk_fma_f32 v[156:157], v[208:209], v[60:61], v[156:157] op_sel_hi:[0,1,1]
v_pk_mul_f32 v[10:11], v[156:157], v[224:225] op_sel_hi:[1,0]
v_pk_fma_f32 v[156:157], v[156:157], v[216:217], s[52:53] op_sel_hi:[1,0,1]
v_exp_f32_e64 v10, v10 clamp
v_exp_f32_e64 v11, v11 clamp
v_max_f32 v156, s52, v156
v_max_f32 v157, s52, v157
v_pk_add_f32 v[156:157], v[156:157], v[10:11]
v_cvt_pk_bf16_f32 v86, v156, v157
v_pk_fma_f32 v[158:159], v[208:209], v[62:63], v[158:159] op_sel_hi:[0,1,1]
v_pk_mul_f32 v[12:13], v[158:159], v[224:225] op_sel_hi:[1,0]
v_pk_fma_f32 v[158:159], v[158:159], v[216:217], s[52:53] op_sel_hi:[1,0,1]
s_cbranch_execz Ldr0
Ldq03:
v_exp_f32_e64 v12, v12 clamp
v_exp_f32_e64 v13, v13 clamp
v_max_f32 v158, s52, v158
v_max_f32 v159, s52, v159
v_pk_add_f32 v[158:159], v[158:159], v[12:13]
v_cvt_pk_bf16_f32 v87, v158, v159
s_cbranch_execz Lqs07
s_add_u32 s34, s33, 3072
buffer_store_dwordx4 v[84:87], v3, s[40:43], s34 offen sc1
Lqs07:
v_pk_fma_f32 v[160:161], v[208:209], v[64:65], v[160:161] op_sel_hi:[0,1,1]
v_pk_mul_f32 v[10:11], v[160:161], v[224:225] op_sel_hi:[1,0]
v_pk_fma_f32 v[160:161], v[160:161], v[216:217], s[52:53] op_sel_hi:[1,0,1]
v_exp_f32_e64 v10, v10 clamp
v_exp_f32_e64 v11, v11 clamp
v_max_f32 v160, s52, v160
v_max_f32 v161, s52, v161
v_pk_add_f32 v[160:161], v[160:161], v[10:11]
v_cvt_pk_bf16_f32 v80, v160, v161
v_pk_fma_f32 v[162:163], v[208:209], v[66:67], v[162:163] op_sel_hi:[0,1,1]
v_pk_mul_f32 v[12:13], v[162:163], v[224:225] op_sel_hi:[1,0]
v_pk_fma_f32 v[162:163], v[162:163], v[216:217], s[52:53] op_sel_hi:[1,0,1]
v_exp_f32_e64 v12, v12 clamp
v_exp_f32_e64 v13, v13 clamp
v_max_f32 v162, s52, v162
v_max_f32 v163, s52, v163
v_pk_add_f32 v[162:163], v[162:163], v[12:13]
v_cvt_pk_bf16_f32 v81, v162, v163
v_pk_fma_f32 v[164:165], v[208:209], v[68:69], v[164:165] op_sel_hi:[0,1,1]
v_pk_mul_f32 v[10:11], v[164:165], v[224:225] op_sel_hi:[1,0]
v_pk_fma_f32 v[164:165], v[164:165], v[216:217], s[52:53] op_sel_hi:[1,0,1]
v_exp_f32_e64 v10, v10 clamp
v_exp_f32_e64 v11, v11 clamp
v_max_f32 v164, s52, v164
v_max_f32 v165, s52, v165
v_pk_add_f32 v[164:165], v[164:165], v[10:11]
v_cvt_pk_bf16_f32 v82, v164, v165
v_pk_fma_f32 v[166:167], v[208:209], v[70:71], v[166:167] op_sel_hi:[0,1,1]
v_pk_mul_f32 v[12:13], v[166:167], v[224:225] op_sel_hi:[1,0]
v_pk_fma_f32 v[166:167], v[166:167], v[216:217], s[52:53] op_sel_hi:[1,0,1]
v_exp_f32_e64 v12, v12 clamp
v_exp_f32_e64 v13, v13 clamp
v_max_f32 v166, s52, v166
v_max_f32 v167, s52, v167
v_pk_add_f32 v[166:167], v[166:167], v[12:13]
v_cvt_pk_bf16_f32 v83, v166, v167
s_cbranch_execz Lqs09
s_add_u32 s34, s33, 4096
buffer_store_dwordx4 v[80:83], v3, s[40:43], s34 offen sc1
Lqs09:
v_pk_fma_f32 v[168:169], v[212:213], v[32:33], v[168:169] op_sel_hi:[0,1,1]
s_cbranch_execz Ldr0
Ldq10:
v_pk_mul_f32 v[10:11], v[168:169], v[228:229] op_sel_hi:[1,0]
v_pk_fma_f32 v[168:169], v[168:169], v[220:221], s[52:53] op_sel_hi:[1,0,1]
v_exp_f32_e64 v10, v10 clamp
v_exp_f32_e64 v11, v11 clamp
v_max_f32 v168, s52, v168
v_max_f32 v169, s52, v169
v_pk_add_f32 v[168:169], v[168:169], v[10:11]
v_cvt_pk_bf16_f32 v88, v168, v169
v_pk_fma_f32 v[170:171], v[212:213], v[34:35], v[170:171] op_sel_hi:[0,1,1]
v_pk_mul_f32 v[12:13], v[170:171], v[228:229] op_sel_hi:[1,0]
v_pk_fma_f32 v[170:171], v[170:171], v[220:221], s[52:53] op_sel_hi:[1,0,1]
v_exp_f32_e64 v12, v12 clamp
v_exp_f32_e64 v13, v13 clamp
v_max_f32 v170, s52, v170
v_max_f32 v171, s52, v171
v_pk_add_f32 v[170:171], v[170:171], v[12:13]
v_cvt_pk_bf16_f32 v89, v170, v171
v_pk_fma_f32 v[172:173], v[212:213], v[36:37], v[172:173] op_sel_hi:[0,1,1]
v_pk_mul_f32 v[10:11], v[172:173], v[228:229] op_sel_hi:[1,0]
v_pk_fma_f32 v[172:173], v[172:173], v[220:221], s[52:53] op_sel_hi:[1,0,1]
v_exp_f32_e64 v10, v10 clamp
v_exp_f32_e64 v11, v11 clamp
v_max_f32 v172, s52, v172
v_max_f32 v173, s52, v173
v_pk_add_f32 v[172:173], v[172:173], v[10:11]
v_cvt_pk_bf16_f32 v90, v172, v173
v_pk_fma_f32 v[174:175], v[212:213], v[38:39], v[174:175] op_sel_hi:[0,1,1]
v_pk_mul_f32 v[12:13], v[174:175], v[228:229] op_sel_hi:[1,0]
v_pk_fma_f32 v[174:175], v[174:175], v[220:221], s[52:53] op_sel_hi:[1,0,1]
v_exp_f32_e64 v12, v12 clamp
v_exp_f32_e64 v13, v13 clamp
v_max_f32 v174, s52, v174
v_max_f32 v175, s52, v175
v_pk_add_f32 v[174:175], v[174:175], v[12:13]
v_cvt_pk_bf16_f32 v91, v174, v175
s_cbranch_execz Lqs11
s_add_u32 s34, s33, 20480
buffer_store_dwordx4 v[88:91], v3, s[40:43], s34 offen sc1
Lqs11:
v_pk_fma_f32 v[176:177], v[212:213], v[40:41], v[176:177] op_sel_hi:[0,1,1]
v_pk_mul_f32 v[10:11], v[176:177], v[228:229] op_sel_hi:[1,0]
v_pk_fma_f32 v[176:177], v[176:177], v[220:221], s[52:53] op_sel_hi:[1,0,1]
v_exp_f32_e64 v10, v10 clamp
v_exp_f32_e64 v11, v11 clamp
v_max_f32 v176, s52, v176
v_max_f32 v177, s52, v177
v_pk_add_f32 v[176:177], v[176:177], v[10:11]
v_cvt_pk_bf16_f32 v92, v176, v177
v_pk_fma_f32 v[178:179], v[212:213], v[42:43], v[178:179] op_sel_hi:[0,1,1]
s_cbranch_execz Ldr1
Ldq11:
v_pk_mul_f32 v[12:13], v[178:179], v[228:229] op_sel_hi:[1,0]
v_pk_fma_f32 v[178:179], v[178:179], v[220:221], s[52:53] op_sel_hi:[1,0,1]
v_exp_f32_e64 v12, v12 clamp
v_exp_f32_e64 v13, v13 clamp
v_max_f32 v178, s52, v178
v_max_f32 v179, s52, v179
v_pk_add_f32 v[178:179], v[178:179], v[12:13]
v_cvt_pk_bf16_f32 v93, v178, v179
v_pk_fma_f32 v[180:181], v[212:213], v[44:45], v[180:181] op_sel_hi:[0,1,1]
v_pk_mul_f32 v[10:11], v[180:181], v[228:229] op_sel_hi:[1,0]
v_pk_fma_f32 v[180:181], v[180:181], v[220:221], s[52:53] op_sel_hi:[1,0,1]
v_exp_f32_e64 v10, v10 clamp
v_exp_f32_e64 v11, v11 clamp
v_max_f32 v180, s52, v180
v_max_f32 v181, s52, v181
v_pk_add_f32 v[180:181], v[180:181], v[10:11]
v_cvt_pk_bf16_f32 v94, v180, v181
v_pk_fma_f32 v[182:183], v[212:213], v[46:47], v[182:183] op_sel_hi:[0,1,1]
v_pk_mul_f32 v[12:13], v[182:183], v[228:229] op_sel_hi:[1,0]
v_pk_fma_f32 v[182:183], v[182:183], v[220:221], s[52:53] op_sel_hi:[1,0,1]
v_exp_f32_e64 v12, v12 clamp
v_exp_f32_e64 v13, v13 clamp
v_max_f32 v182, s52, v182
v_max_f32 v183, s52, v183
v_pk_add_f32 v[182:183], v[182:183], v[12:13]
v_cvt_pk_bf16_f32 v95, v182, v183
s_cbranch_execz Lqs13
s_add_u32 s34, s33, 21504
buffer_store_dwordx4 v[92:95], v3, s[40:43], s34 offen sc1
Lqs13:
v_pk_fma_f32 v[184:185], v[212:213], v[48:49], v[184:185] op_sel_hi:[0,1,1]
v_pk_mul_f32 v[10:11], v[184:185], v[228:229] op_sel_hi:[1,0]
v_pk_fma_f32 v[184:185], v[184:185], v[220:221], s[52:53] op_sel_hi:[1,0,1]
v_exp_f32_e64 v10, v10 clamp
v_exp_f32_e64 v11, v11 clamp
v_max_f32 v184, s52, v184
v_max_f32 v185, s52, v185
v_pk_add_f32 v[184:185], v[184:185], v[10:11]
v_cvt_pk_bf16_f32 v88, v184, v185
v_pk_fma_f32 v[186:187], v[212:213], v[50:51], v[186:187] op_sel_hi:[0,1,1]
v_pk_mul_f32 v[12:13], v[186:187], v[228:229] op_sel_hi:[1,0]
v_pk_fma_f32 v[186:187], v[186:187], v[220:221], s[52:53] op_sel_hi:[1,0,1]
v_exp_f32_e64 v12, v12 clamp
v_exp_f32_e64 v13, v13 clamp
v_max_f32 v186, s52, v186
v_max_f32 v187, s52, v187
v_pk_add_f32 v[186:187], v[186:187], v[12:13]
v_cvt_pk_bf16_f32 v89, v186, v187
v_pk_fma_f32 v[188:189], v[212:213], v[52:53], v[188:189] op_sel_hi:[0,1,1]
v_pk_mul_f32 v[10:11], v[188:189], v[228:229] op_sel_hi:[1,0]
s_cbranch_execz Ldr1
Ldq12:
v_pk_fma_f32 v[188:189], v[188:189], v[220:221], s[52:53] op_sel_hi:[1,0,1]
v_exp_f32_e64 v10, v10 clamp
v_exp_f32_e64 v11, v11 clamp
v_max_f32 v188, s52, v188
v_max_f32 v189, s52, v189
v_pk_add_f32 v[188:189], v[188:189], v[10:11]
v_cvt_pk_bf16_f32 v90, v188, v189
v_pk_fma_f32 v[190:191], v[212:213], v[54:55], v[190:191] op_sel_hi:[0,1,1]
v_pk_mul_f32 v[12:13], v[190:191], v[228:229] op_sel_hi:[1,0]
v_pk_fma_f32 v[190:191], v[190:191], v[220:221], s[52:53] op_sel_hi:[1,0,1]
v_exp_f32_e64 v12, v12 clamp
v_exp_f32_e64 v13, v13 clamp
v_max_f32 v190, s52, v190
v_max_f32 v191, s52, v191
v_pk_add_f32 v[190:191], v[190:191], v[12:13]
v_cvt_pk_bf16_f32 v91, v190, v191
s_cbranch_execz Lqs15
s_add_u32 s34, s33, 22528
buffer_store_dwordx4 v[88:91], v3, s[40:43], s34 offen sc1
Lqs15:
v_pk_fma_f32 v[192:193], v[212:213], v[56:57], v[192:193] op_sel_hi:[0,1,1]
v_pk_mul_f32 v[10:11], v[192:193], v[228:229] op_sel_hi:[1,0]
v_pk_fma_f32 v[192:193], v[192:193], v[220:221], s[52:53] op_sel_hi:[1,0,1]
v_exp_f32_e64 v10, v10 clamp
v_exp_f32_e64 v11, v11 clamp
v_max_f32 v192, s52, v192
v_max_f32 v193, s52, v193
v_pk_add_f32 v[192:193], v[192:193], v[10:11]
v_cvt_pk_bf16_f32 v92, v192, v193
v_pk_fma_f32 v[194:195], v[212:213], v[58:59], v[194:195] op_sel_hi:[0,1,1]
v_pk_mul_f32 v[12:13], v[194:195], v[228:229] op_sel_hi:[1,0]
v_pk_fma_f32 v[194:195], v[194:195], v[220:221], s[52:53] op_sel_hi:[1,0,1]
v_exp_f32_e64 v12, v12 clamp
v_exp_f32_e64 v13, v13 clamp
v_max_f32 v194, s52, v194
v_max_f32 v195, s52, v195
v_pk_add_f32 v[194:195], v[194:195], v[12:13]
v_cvt_pk_bf16_f32 v93, v194, v195
v_pk_fma_f32 v[196:197], v[212:213], v[60:61], v[196:197] op_sel_hi:[0,1,1]
v_pk_mul_f32 v[10:11], v[196:197], v[228:229] op_sel_hi:[1,0]
v_pk_fma_f32 v[196:197], v[196:197], v[220:221], s[52:53] op_sel_hi:[1,0,1]
v_exp_f32_e64 v10, v10 clamp
v_exp_f32_e64 v11, v11 clamp
v_max_f32 v196, s52, v196
v_max_f32 v197, s52, v197
v_pk_add_f32 v[196:197], v[196:197], v[10:11]
v_cvt_pk_bf16_f32 v94, v196, v197
v_pk_fma_f32 v[198:199], v[212:213], v[62:63], v[198:199] op_sel_hi:[0,1,1]
v_pk_mul_f32 v[12:13], v[198:199], v[228:229] op_sel_hi:[1,0]
v_pk_fma_f32 v[198:199], v[198:199], v[220:221], s[52:53] op_sel_hi:[1,0,1]
s_cbranch_execz Ldr1
Ldq13:
v_exp_f32_e64 v12, v12 clamp
v_exp_f32_e64 v13, v13 clamp
v_max_f32 v198, s52, v198
v_max_f32 v199, s52, v199
v_pk_add_f32 v[198:199], v[198:199], v[12:13]
v_cvt_pk_bf16_f32 v95, v198, v199
s_cbranch_execz Lqs17
s_add_u32 s34, s33, 23552
buffer_store_dwordx4 v[92:95], v3, s[40:43], s34 offen sc1
Lqs17:
v_pk_fma_f32 v[200:201], v[212:213], v[64:65], v[200:201] op_sel_hi:[0,1,1]
v_pk_mul_f32 v[10:11], v[200:201], v[228:229] op_sel_hi:[1,0]
v_pk_fma_f32 v[200:201], v[200:201], v[220:221], s[52:53] op_sel_hi:[1,0,1]
v_exp_f32_e64 v10, v10 clamp
v_exp_f32_e64 v11, v11 clamp
v_max_f32 v200, s52, v200
v_max_f32 v201, s52, v201
v_pk_add_f32 v[200:201], v[200:201], v[10:11]
v_cvt_pk_bf16_f32 v88, v200, v201
v_pk_fma_f32 v[202:203], v[212:213], v[66:67], v[202:203] op_sel_hi:[0,1,1]
v_pk_mul_f32 v[12:13], v[202:203], v[228:229] op_sel_hi:[1,0]
v_pk_fma_f32 v[202:203], v[202:203], v[220:221], s[52:53] op_sel_hi:[1,0,1]
v_exp_f32_e64 v12, v12 clamp
v_exp_f32_e64 v13, v13 clamp
v_max_f32 v202, s52, v202
v_max_f32 v203, s52, v203
v_pk_add_f32 v[202:203], v[202:203], v[12:13]
v_cvt_pk_bf16_f32 v89, v202, v203
v_pk_fma_f32 v[204:205], v[212:213], v[68:69], v[204:205] op_sel_hi:[0,1,1]
v_pk_mul_f32 v[10:11], v[204:205], v[228:229] op_sel_hi:[1,0]
v_pk_fma_f32 v[204:205], v[204:205], v[220:221], s[52:53] op_sel_hi:[1,0,1]
v_exp_f32_e64 v10, v10 clamp
v_exp_f32_e64 v11, v11 clamp
v_max_f32 v204, s52, v204
v_max_f32 v205, s52, v205
v_pk_add_f32 v[204:205], v[204:205], v[10:11]
v_cvt_pk_bf16_f32 v90, v204, v205
v_pk_fma_f32 v[206:207], v[212:213], v[70:71], v[206:207] op_sel_hi:[0,1,1]
v_pk_mul_f32 v[12:13], v[206:207], v[228:229] op_sel_hi:[1,0]
v_pk_fma_f32 v[206:207], v[206:207], v[220:221], s[52:53] op_sel_hi:[1,0,1]
v_exp_f32_e64 v12, v12 clamp
v_exp_f32_e64 v13, v13 clamp
v_max_f32 v206, s52, v206
v_max_f32 v207, s52, v207
v_pk_add_f32 v[206:207], v[206:207], v[12:13]
v_cvt_pk_bf16_f32 v91, v206, v207
s_cbranch_execz Lqs19
s_add_u32 s34, s33, 24576
buffer_store_dwordx4 v[88:91], v3, s[40:43], s34 offen sc1
Lqs19:
s_cbranch_execz Ldr1
s_branch LC2b
Lhelp:
s_sub_u32 s27, s26, 24
s_lshl3_add_u32 s28, s25, s27
s_lshl3_add_u32 s27, s27, s25
s_lshl3_add_u32 s28, s28, s24
s_mul_i32 s29, s28, 5120
v_mul_u32_u24 v4, 1280, v1
v_lshl_add_u32 v4, v2, 4, v4
s_waitcnt lgkmcnt(0)
s_mov_b64 s[44:45], s[22:23]
s_mov_b32 s46, 0
s_mov_b32 s47, 0x20000
s_mov_b32 s56, s4
s_mov_b32 s57, s5
s_mov_b32 s58, 2621440
s_mov_b32 s59, 0x20000
s_mov_b32 s40, s22
s_mov_b32 s41, s23
s_mov_b32 s42, 33554432
s_mov_b32 s43, 0x20000
buffer_load_dwordx4 v[100:103], v4, s[56:59], s29 offen offset:0
buffer_load_dwordx4 v[104:107], v4, s[56:59], s29 offen offset:256
buffer_load_dwordx4 v[108:111], v4, s[56:59], s29 offen offset:512
buffer_load_dwordx4 v[112:115], v4, s[56:59], s29 offen offset:768
buffer_load_dwordx4 v[116:119], v4, s[56:59], s29 offen offset:1024
v_lshrrev_b32 v24, 2, v0
v_lshlrev_b32 v24, 7, v24
v_and_b32 v4, 3, v0
v_lshl_add_u32 v24, v4, 3, v24
s_lshl_b32 s37, s24, 14
v_add_u32 v24, s37, v24
v_lshlrev_b32 v25, 4, v1
v_cmp_eq_u32 vcc, 0, v2
v_mov_b32 v6, 1073741824
v_lshlrev_b32 v26, 2, v1
v_cndmask_b32 v25, v6, v25, vcc
v_cndmask_b32 v26, v6, v26, vcc
v_mov_b32 v28, 0x3f803f80
v_mov_b32 v8, 0
v_mov_b32 v29, 0x3f803f80
v_mov_b32 v9, 0
v_mov_b32 v30, 0x3f803f80
v_mov_b32 v10, 0
v_mov_b32 v31, 0x3f803f80
v_mov_b32 v11, 0
s_cmp_lg_u32 s24, 1
s_cbranch_scc1 Lht
v_mul_u32_u24 v5, 30720, v0
v_and_b32 v4, 3, v0
v_lshlrev_b32 v4, 21, v4
s_mov_b32 s30, 0x10f0000
Lht:
s_cmp_gt_u32 s27, 9
s_cbranch_scc1 Lhz
s_cmp_lg_u32 s24, 0
s_cbranch_scc1 Lhz
s_mul_i32 s30, s27, 6720
s_add_u32 s30, s30, 3145728
s_cmp_eq_u32 s27, 8
s_cselect_b32 s30, 3670016, s30
s_cmp_eq_u32 s27, 9
s_cselect_b32 s30, 3677184, s30
buffer_store_dwordx4 v[8:11], v3, s[40:43], s30 offen sc1
s_add_u32 s30, s30, 1024
buffer_store_dwordx4 v[8:11], v3, s[40:43], s30 offen sc1
s_add_u32 s30, s30, 1024
buffer_store_dwordx4 v[8:11], v3, s[40:43], s30 offen sc1
s_add_u32 s30, s30, 1024
buffer_store_dwordx4 v[8:11], v3, s[40:43], s30 offen sc1
s_add_u32 s30, s30, 1024
buffer_store_dwordx4 v[8:11], v3, s[40:43], s30 offen sc1
s_add_u32 s30, s30, 1024
buffer_store_dwordx4 v[8:11], v3, s[40:43], s30 offen sc1
s_add_u32 s30, s30, 1024
buffer_store_dwordx4 v[8:11], v3, s[40:43], s30 offen sc1
s_add_u32 s30, s30, 1024
Lhz:
s_lshl_b32 s30, s24, 6
s_add_u32 s30, s30, s27
s_sub_u32 s31, s30, 362
s_lshr_b32 s31, s31, 1
s_mul_i32 s32, s31, 41
s_lshr_b32 s32, s32, 10
s_add_u32 s32, s32, s77
s_mul_i32 s32, s32, 25
s_add_u32 s31, s31, s32
s_add_u32 s31, s31, 432
s_cmp_lt_u32 s30, 362
s_cselect_b32 s30, s30, s31
s_add_u32 s30, s30, 48
s_mov_b32 s60, 0
s_cmp_ge_u32 s30, 360
s_cbranch_scc1 Lhj
s_waitcnt vmcnt(0)
v_mov_b32 v6, 0
v_mov_b32 v7, 0
v_dot2_f32_bf16 v6, v100, v28, v6
v_dot2_f32_bf16 v7, v100, v100, v7
v_dot2_f32_bf16 v6, v101, v28, v6
v_dot2_f32_bf16 v7, v101, v101, v7
v_dot2_f32_bf16 v6, v102, v28, v6
v_dot2_f32_bf16 v7, v102, v102, v7
v_dot2_f32_bf16 v6, v103, v28, v6
v_dot2_f32_bf16 v7, v103, v103, v7
v_dot2_f32_bf16 v6, v104, v28, v6
v_dot2_f32_bf16 v7, v104, v104, v7
v_dot2_f32_bf16 v6, v105, v28, v6
v_dot2_f32_bf16 v7, v105, v105, v7
v_dot2_f32_bf16 v6, v106, v28, v6
v_dot2_f32_bf16 v7, v106, v106, v7
v_dot2_f32_bf16 v6, v107, v28, v6
v_dot2_f32_bf16 v7, v107, v107, v7
v_dot2_f32_bf16 v6, v108, v28, v6
v_dot2_f32_bf16 v7, v108, v108, v7
v_dot2_f32_bf16 v6, v109, v28, v6
v_dot2_f32_bf16 v7, v109, v109, v7
v_dot2_f32_bf16 v6, v110, v28, v6
v_dot2_f32_bf16 v7, v110, v110, v7
v_dot2_f32_bf16 v6, v111, v28, v6
v_dot2_f32_bf16 v7, v111, v111, v7
v_dot2_f32_bf16 v6, v112, v28, v6
v_dot2_f32_bf16 v7, v112, v112, v7
v_dot2_f32_bf16 v6, v113, v28, v6
v_dot2_f32_bf16 v7, v113, v113, v7
v_dot2_f32_bf16 v6, v114, v28, v6
v_dot2_f32_bf16 v7, v114, v114, v7
v_dot2_f32_bf16 v6, v115, v28, v6
v_dot2_f32_bf16 v7, v115, v115, v7
v_dot2_f32_bf16 v6, v116, v28, v6
v_dot2_f32_bf16 v7, v116, v116, v7
v_dot2_f32_bf16 v6, v117, v28, v6
v_dot2_f32_bf16 v7, v117, v117, v7
v_dot2_f32_bf16 v6, v118, v28, v6
v_dot2_f32_bf16 v7, v118, v118, v7
v_dot2_f32_bf16 v6, v119, v28, v6
v_dot2_f32_bf16 v7, v119, v119, v7
s_nop 1
v_add_f32_dpp v6, v6, v6 row_ror:8 row_mask:0xf bank_mask:0xf
v_add_f32_dpp v7, v7, v7 row_ror:8 row_mask:0xf bank_mask:0xf
s_nop 0
v_add_f32_dpp v6, v6, v6 row_ror:4 row_mask:0xf bank_mask:0xf
v_add_f32_dpp v7, v7, v7 row_ror:4 row_mask:0xf bank_mask:0xf
s_nop 0
v_add_f32_dpp v6, v6, v6 row_ror:2 row_mask:0xf bank_mask:0xf
v_add_f32_dpp v7, v7, v7 row_ror:2 row_mask:0xf bank_mask:0xf
s_nop 0
v_add_f32_dpp v6, v6, v6 row_ror:1 row_mask:0xf bank_mask:0xf
v_add_f32_dpp v7, v7, v7 row_ror:1 row_mask:0xf bank_mask:0xf
v_mul_f32 v6, 0xbacccccd, v6
v_mul_f32 v7, 0x3acccccd, v7
v_fma_f32 v7, -v6, v6, v7
v_max_f32 v7, 0, v7
v_add_f32 v7, 0x3727c5ac, v7
v_rsq_f32 v7, v7
s_lshl_b32 s29, s28, 4
s_add_u32 s29, s29, 3538944
s_add_u32 s61, s29, 8192
buffer_store_dword v6, v26, s[40:43], s29 offen sc1
buffer_store_dword v7, v26, s[40:43], s61 offen sc1
s_sub_u32 s30, s30, 48
s_cmp_ge_u32 s24, 0
s_cbranch_scc1 Lhb
Lhj:
s_mul_i32 s48, s30, 547
s_lshr_b32 s48, s48, 16
s_min_u32 s48, s48, 4
s_mul_i32 s29, s48, 120
s_sub_u32 s29, s30, s29
s_mov_b32 s31, 13108
s_mov_b32 s46, 1966080
s_mov_b32 s34, 1280
s_cmp_eq_u32 s48, 2
s_cselect_b32 s30, 12, 5
s_cselect_b32 s31, 5462, s31
s_cselect_b32 s32, 48, 20
s_mul_i32 s31, s29, s31
s_lshr_b32 s31, s31, 16
s_mul_i32 s30, s31, s30
s_sub_u32 s30, s29, s30
s_mov_b32 s44, s12
s_mov_b32 s45, s13
s_mov_b32 s33, 17825792
s_cmp_eq_u32 s48, 1
s_cselect_b32 s44, s14, s44
s_cselect_b32 s45, s15, s45
s_cselect_b32 s33, 19922944, s33
s_cmp_eq_u32 s48, 2
s_cselect_b32 s44, s16, s44
s_cselect_b32 s45, s17, s45
s_cselect_b32 s33, 22020096, s33
s_cmp_eq_u32 s48, 3
s_cselect_b32 s44, s8, s44
s_cselect_b32 s45, s9, s45
s_cselect_b32 s33, 16777216, s33
s_cselect_b32 s46, 819200, s46
s_cmp_lt_u32 s48, 2
s_cselect_b32 s34, 3072, s34
s_mul_i32 s38, s30, 12288
s_mul_i32 s39, s48, 6144
s_add_u32 s38, s38, s39
s_add_u32 s38, s38, 3276800
s_mul_i32 s39, s30, 7680
s_add_u32 s39, s39, 3571712
s_cmp_eq_u32 s48, 4
s_cselect_b32 s44, s6, s44
s_cselect_b32 s45, s7, s45
s_cselect_b32 s46, 2457600, s46
s_cselect_b32 s34, 3840, s34
s_cselect_b32 s38, s39, s38
s_lshl_b32 s39, s31, 8
s_add_u32 s38, s38, s39
s_mov_b32 s47, 0x20000
v_lshrrev_b32 v5, 3, v0
v_mul_lo_u32 v5, v5, s34
v_and_b32 v4, 7, v0
v_lshl_add_u32 v5, v4, 4, v5
s_mul_i32 s35, s30, s34
s_add_u32 s35, s35, s31
s_lshl_b32 s35, s35, 7
s_lshl_b32 s36, s34, 3
s_mov_b32 m0, s37
s_mov_b32 s39, 0
Lhl:
buffer_load_dwordx4 v5, s[44:47], s35 offen lds
s_add_u32 m0, m0, 1024
s_add_u32 s35, s35, s36
s_add_u32 s39, s39, 1
s_cmp_lt_u32 s39, 16
s_cbranch_scc1 Lhl
s_mul_i32 s35, s31, s32
s_add_u32 s35, s35, s30
s_lshl_b32 s35, s35, 12
s_add_u32 s35, s35, s33
s_lshl_b32 s36, s32, 10
s_cmp_lg_u32 s60, 0
s_cbranch_scc1 Lhr
s_waitcnt vmcnt(16)
s_cmp_ge_u32 s48, 3
s_cbranch_scc1 Lhq
s_barrier
s_barrier
s_branch Lhr
Lhq:
v_mov_b32 v6, 0
v_mov_b32 v7, 0
v_dot2_f32_bf16 v6, v100, v28, v6
v_dot2_f32_bf16 v7, v100, v100, v7
v_dot2_f32_bf16 v6, v101, v28, v6
v_dot2_f32_bf16 v7, v101, v101, v7
v_dot2_f32_bf16 v6, v102, v28, v6
v_dot2_f32_bf16 v7, v102, v102, v7
v_dot2_f32_bf16 v6, v103, v28, v6
v_dot2_f32_bf16 v7, v103, v103, v7
v_dot2_f32_bf16 v6, v104, v28, v6
v_dot2_f32_bf16 v7, v104, v104, v7
v_dot2_f32_bf16 v6, v105, v28, v6
v_dot2_f32_bf16 v7, v105, v105, v7
v_dot2_f32_bf16 v6, v106, v28, v6
v_dot2_f32_bf16 v7, v106, v106, v7
v_dot2_f32_bf16 v6, v107, v28, v6
v_dot2_f32_bf16 v7, v107, v107, v7
v_dot2_f32_bf16 v6, v108, v28, v6
v_dot2_f32_bf16 v7, v108, v108, v7
v_dot2_f32_bf16 v6, v109, v28, v6
v_dot2_f32_bf16 v7, v109, v109, v7
v_dot2_f32_bf16 v6, v110, v28, v6
v_dot2_f32_bf16 v7, v110, v110, v7
v_dot2_f32_bf16 v6, v111, v28, v6
v_dot2_f32_bf16 v7, v111, v111, v7
v_dot2_f32_bf16 v6, v112, v28, v6
v_dot2_f32_bf16 v7, v112, v112, v7
v_dot2_f32_bf16 v6, v113, v28, v6
v_dot2_f32_bf16 v7, v113, v113, v7
v_dot2_f32_bf16 v6, v114, v28, v6
v_dot2_f32_bf16 v7, v114, v114, v7
v_dot2_f32_bf16 v6, v115, v28, v6
v_dot2_f32_bf16 v7, v115, v115, v7
v_dot2_f32_bf16 v6, v116, v28, v6
v_dot2_f32_bf16 v7, v116, v116, v7
v_dot2_f32_bf16 v6, v117, v28, v6
v_dot2_f32_bf16 v7, v117, v117, v7
v_dot2_f32_bf16 v6, v118, v28, v6
v_dot2_f32_bf16 v7, v118, v118, v7
v_dot2_f32_bf16 v6, v119, v28, v6
v_dot2_f32_bf16 v7, v119, v119, v7
s_nop 1
v_add_f32_dpp v6, v6, v6 row_ror:8 row_mask:0xf bank_mask:0xf
v_add_f32_dpp v7, v7, v7 row_ror:8 row_mask:0xf bank_mask:0xf
s_nop 0
v_add_f32_dpp v6, v6, v6 row_ror:4 row_mask:0xf bank_mask:0xf
v_add_f32_dpp v7, v7, v7 row_ror:4 row_mask:0xf bank_mask:0xf
s_nop 0
v_add_f32_dpp v6, v6, v6 row_ror:2 row_mask:0xf bank_mask:0xf
v_add_f32_dpp v7, v7, v7 row_ror:2 row_mask:0xf bank_mask:0xf
s_nop 0
v_add_f32_dpp v6, v6, v6 row_ror:1 row_mask:0xf bank_mask:0xf
v_add_f32_dpp v7, v7, v7 row_ror:1 row_mask:0xf bank_mask:0xf
v_mul_f32 v6, 0xbacccccd, v6
v_mul_f32 v7, 0x3acccccd, v7
v_fma_f32 v7, -v6, v6, v7
v_max_f32 v7, 0, v7
v_add_f32 v7, 0x3727c5ac, v7
v_rsq_f32 v7, v7
s_lshl_b32 s29, s28, 4
s_add_u32 s29, s29, 3538944
s_add_u32 s61, s29, 8192
buffer_store_dword v6, v26, s[40:43], s29 offen sc1
buffer_store_dword v7, v26, s[40:43], s61 offen sc1
s_waitcnt vmcnt(2)
s_branch Lhr2
Lhr:
s_waitcnt vmcnt(0)
Lhr2:
s_add_u32 s62, s35, s36
s_add_u32 s63, s62, s36
s_add_u32 s64, s63, s36
ds_read_b64_tr_b16 v[32:33], v24 offset:0
ds_read_b64_tr_b16 v[34:35], v24 offset:2048
ds_read_b64_tr_b16 v[48:49], v24 offset:32
ds_read_b64_tr_b16 v[50:51], v24 offset:2080
ds_read_b64_tr_b16 v[64:65], v24 offset:64
ds_read_b64_tr_b16 v[66:67], v24 offset:2112
ds_read_b64_tr_b16 v[80:81], v24 offset:96
ds_read_b64_tr_b16 v[82:83], v24 offset:2144
s_waitcnt lgkmcnt(0)
s_cmp_eq_u32 s48, 4
s_cbranch_scc1 Lhn0
s_cmp_eq_u32 s48, 3
s_cbranch_scc1 Lhs0
v_permlane32_swap_b32 v32, v34
v_permlane32_swap_b32 v33, v35
v_permlane32_swap_b32 v48, v50
v_permlane32_swap_b32 v49, v51
v_permlane32_swap_b32 v64, v66
v_permlane32_swap_b32 v65, v67
v_permlane32_swap_b32 v80, v82
v_permlane32_swap_b32 v81, v83
Lhs0:
buffer_store_dwordx4 v[32:35], v3, s[40:43], s35 offen offset:0 sc1
buffer_store_dwordx4 v[48:51], v3, s[40:43], s62 offen offset:0 sc1
buffer_store_dwordx4 v[64:67], v3, s[40:43], s63 offen offset:0 sc1
buffer_store_dwordx4 v[80:83], v3, s[40:43], s64 offen offset:0 sc1
Lhn0:
ds_read_b64_tr_b16 v[36:37], v24 offset:4096
ds_read_b64_tr_b16 v[38:39], v24 offset:6144
ds_read_b64_tr_b16 v[52:53], v24 offset:4128
ds_read_b64_tr_b16 v[54:55], v24 offset:6176
ds_read_b64_tr_b16 v[68:69], v24 offset:4160
ds_read_b64_tr_b16 v[70:71], v24 offset:6208
ds_read_b64_tr_b16 v[84:85], v24 offset:4192
ds_read_b64_tr_b16 v[86:87], v24 offset:6240
s_waitcnt lgkmcnt(0)
s_cmp_eq_u32 s48, 4
s_cbranch_scc1 Lhn1
s_cmp_eq_u32 s48, 3
s_cbranch_scc1 Lhs1
v_permlane32_swap_b32 v36, v38
v_permlane32_swap_b32 v37, v39
v_permlane32_swap_b32 v52, v54
v_permlane32_swap_b32 v53, v55
v_permlane32_swap_b32 v68, v70
v_permlane32_swap_b32 v69, v71
v_permlane32_swap_b32 v84, v86
v_permlane32_swap_b32 v85, v87
Lhs1:
buffer_store_dwordx4 v[36:39], v3, s[40:43], s35 offen offset:1024 sc1
buffer_store_dwordx4 v[52:55], v3, s[40:43], s62 offen offset:1024 sc1
buffer_store_dwordx4 v[68:71], v3, s[40:43], s63 offen offset:1024 sc1
buffer_store_dwordx4 v[84:87], v3, s[40:43], s64 offen offset:1024 sc1
Lhn1:
ds_read_b64_tr_b16 v[40:41], v24 offset:8192
ds_read_b64_tr_b16 v[42:43], v24 offset:10240
ds_read_b64_tr_b16 v[56:57], v24 offset:8224
ds_read_b64_tr_b16 v[58:59], v24 offset:10272
ds_read_b64_tr_b16 v[72:73], v24 offset:8256
ds_read_b64_tr_b16 v[74:75], v24 offset:10304
ds_read_b64_tr_b16 v[88:89], v24 offset:8288
ds_read_b64_tr_b16 v[90:91], v24 offset:10336
s_waitcnt lgkmcnt(0)
s_cmp_eq_u32 s48, 4
s_cbranch_scc1 Lhn2
s_cmp_eq_u32 s48, 3
s_cbranch_scc1 Lhs2
v_permlane32_swap_b32 v40, v42
v_permlane32_swap_b32 v41, v43
v_permlane32_swap_b32 v56, v58
v_permlane32_swap_b32 v57, v59
v_permlane32_swap_b32 v72, v74
v_permlane32_swap_b32 v73, v75
v_permlane32_swap_b32 v88, v90
v_permlane32_swap_b32 v89, v91
Lhs2:
buffer_store_dwordx4 v[40:43], v3, s[40:43], s35 offen offset:2048 sc1
buffer_store_dwordx4 v[56:59], v3, s[40:43], s62 offen offset:2048 sc1
buffer_store_dwordx4 v[72:75], v3, s[40:43], s63 offen offset:2048 sc1
buffer_store_dwordx4 v[88:91], v3, s[40:43], s64 offen offset:2048 sc1
Lhn2:
ds_read_b64_tr_b16 v[44:45], v24 offset:12288
ds_read_b64_tr_b16 v[46:47], v24 offset:14336
ds_read_b64_tr_b16 v[60:61], v24 offset:12320
ds_read_b64_tr_b16 v[62:63], v24 offset:14368
ds_read_b64_tr_b16 v[76:77], v24 offset:12352
ds_read_b64_tr_b16 v[78:79], v24 offset:14400
ds_read_b64_tr_b16 v[92:93], v24 offset:12384
ds_read_b64_tr_b16 v[94:95], v24 offset:14432
s_waitcnt lgkmcnt(0)
s_cmp_eq_u32 s48, 4
s_cbranch_scc1 Lhn3
s_cmp_eq_u32 s48, 3
s_cbranch_scc1 Lhs3
v_permlane32_swap_b32 v44, v46
v_permlane32_swap_b32 v45, v47
v_permlane32_swap_b32 v60, v62
v_permlane32_swap_b32 v61, v63
v_permlane32_swap_b32 v76, v78
v_permlane32_swap_b32 v77, v79
v_permlane32_swap_b32 v92, v94
v_permlane32_swap_b32 v93, v95
Lhs3:
buffer_store_dwordx4 v[44:47], v3, s[40:43], s35 offen offset:3072 sc1
buffer_store_dwordx4 v[60:63], v3, s[40:43], s62 offen offset:3072 sc1
buffer_store_dwordx4 v[76:79], v3, s[40:43], s63 offen offset:3072 sc1
buffer_store_dwordx4 v[92:95], v3, s[40:43], s64 offen offset:3072 sc1
Lhn3:
s_cmp_eq_u32 s48, 4
s_cbranch_scc1 Lhc
s_cmp_ge_u32 s48, 2
s_cbranch_scc1 Lhe
Lhc:
v_mfma_f32_16x16x32_bf16 v[8:11], v[32:35], v[28:31], 0
v_mfma_f32_16x16x32_bf16 v[12:15], v[48:51], v[28:31], 0
v_mfma_f32_16x16x32_bf16 v[16:19], v[64:67], v[28:31], 0
v_mfma_f32_16x16x32_bf16 v[20:23], v[80:83], v[28:31], 0
v_mfma_f32_16x16x32_bf16 v[8:11], v[36:39], v[28:31], v[8:11]
v_mfma_f32_16x16x32_bf16 v[12:15], v[52:55], v[28:31], v[12:15]
v_mfma_f32_16x16x32_bf16 v[16:19], v[68:71], v[28:31], v[16:19]
v_mfma_f32_16x16x32_bf16 v[20:23], v[84:87], v[28:31], v[20:23]
v_mfma_f32_16x16x32_bf16 v[8:11], v[40:43], v[28:31], v[8:11]
v_mfma_f32_16x16x32_bf16 v[12:15], v[56:59], v[28:31], v[12:15]
v_mfma_f32_16x16x32_bf16 v[16:19], v[72:75], v[28:31], v[16:19]
v_mfma_f32_16x16x32_bf16 v[20:23], v[88:91], v[28:31], v[20:23]
v_mfma_f32_16x16x32_bf16 v[8:11], v[44:47], v[28:31], v[8:11]
v_mfma_f32_16x16x32_bf16 v[12:15], v[60:63], v[28:31], v[12:15]
v_mfma_f32_16x16x32_bf16 v[16:19], v[76:79], v[28:31], v[16:19]
v_mfma_f32_16x16x32_bf16 v[20:23], v[92:95], v[28:31], v[20:23]
s_nop 4
buffer_store_dwordx4 v[8:11], v25, s[40:43], s38 offen offset:0 sc1
buffer_store_dwordx4 v[12:15], v25, s[40:43], s38 offen offset:64 sc1
buffer_store_dwordx4 v[16:19], v25, s[40:43], s38 offen offset:128 sc1
buffer_store_dwordx4 v[20:23], v25, s[40:43], s38 offen offset:192 sc1
Lhe:
s_cmp_lt_u32 s48, 3
s_cbranch_scc1 Lhd
Lhb:
s_waitcnt vmcnt(0)
s_barrier
s_cmp_lg_u32 s24, 7
s_cbranch_scc1 Lh7
v_mov_b32 v4, 1
v_mov_b32 v27, 0
s_mov_b64 exec, 1
global_atomic_add v5, v27, v4, s[20:21] offset:128 sc0
v_mov_b32 v4, 64
s_waitcnt vmcnt(0)
v_cmp_eq_u32 vcc, 63, v5
s_nop 4
s_cbranch_vccz Lhf
global_store_dword v27, v4, s[20:21] offset:0 sc1
Lhf:
s_mov_b64 exec, -1
Lh7:
s_barrier
s_mov_b32 s60, 1
s_mul_i32 s30, s27, 52
s_lshr_b32 s30, s30, 8
s_mul_i32 s30, s30, 25
s_cmp_ge_u32 s27, 52
s_cselect_b32 s31, 48, 0
s_add_u32 s31, s31, 200
s_cmp_ge_u32 s27, 40
s_cselect_b32 s30, s31, s30
s_cselect_b32 s31, 12, 5
s_cselect_b32 s32, 5, 6
s_mul_i32 s31, s31, s24
s_add_u32 s30, s30, s27
s_add_u32 s30, s30, s31
s_cmp_lt_u32 s24, s32
s_cbranch_scc1 Lhj
Lhd:
s_mov_b32 s54, 3685376
s_mov_b32 s80, 3685504
s_cmp_lt_u32 s24, 4
s_cbranch_scc1 LC2
v_mov_b32 v17, 0
global_load_dword v16, v17, s[20:21] sc1
s_waitcnt vmcnt(0)
s_barrier
v_mov_b32 v4, 45312
v_mov_b32 v6, 0
v_mov_b32 v7, 0
ds_write_b64 v4, v[6:7]
s_mov_b32 s75, 0
s_branch Lhpc
Lhp:
global_load_dword v16, v17, s[20:21] sc1
s_waitcnt vmcnt(0)
Lhpc:
v_cmp_gt_u32 vcc, 64, v16
s_add_u32 s75, s75, 1
s_cmp_ge_u32 s75, 0x8000
s_cbranch_scc1 Lhpd
s_nop 1
s_cbranch_vccnz Lhp
Lhpd:
s_waitcnt lgkmcnt(0)
s_cmp_eq_u32 s24, 7
s_cbranch_scc1 Lhu
s_barrier
s_branch Lhv
Lhu:
v_mov_b32 v4, 1
v_mov_b32 v27, 0
s_mov_b64 exec, 1
global_atomic_add v5, v27, v4, s[20:21] offset:132 sc0
s_barrier
v_mov_b32 v4, 64
s_waitcnt vmcnt(0)
v_cmp_eq_u32 vcc, 63, v5
s_nop 4
s_cbranch_vccz Lhw
global_store_dword v27, v4, s[20:21] offset:4 sc1
Lhw:
s_mov_b64 exec, -1
Lhv:
s_lshr_b32 s27, s26, 2
s_lshl3_add_u32 s27, s76, s27
s_and_b32 s28, s26, 3
s_lshl2_add_u32 s28, s77, s28
s_lshl2_add_u32 s29, s27, s78
s_lshr_b32 s60, s27, 1
s_and_b32 s61, s26, 7
s_lshl3_add_u32 s61, s77, s61
s_mul_i32 s30, s28, 102400
s_mul_i32 s31, s78, 5120
s_add_u32 s30, s30, s31
s_add_u32 s30, s30, 16777216
s_mul_i32 s31, s78, 10240
s_add_u32 m0, s31, 122880
s_add_u32 s32, s30, 0
buffer_load_dwordx4 v3, s[40:43], s32 offen offset:0 sc1 lds
buffer_load_dwordx4 v3, s[40:43], s32 offen offset:1024 sc1 lds
buffer_load_dwordx4 v3, s[40:43], s32 offen offset:2048 sc1 lds
buffer_load_dwordx4 v3, s[40:43], s32 offen offset:3072 sc1 lds
s_add_u32 m0, s31, 126976
s_add_u32 s32, s32, 4096
buffer_load_dwordx4 v3, s[40:43], s32 offen sc1 lds
s_add_u32 m0, s31, 128000
s_add_u32 s32, s30, 20480
buffer_load_dwordx4 v3, s[40:43], s32 offen offset:0 sc1 lds
buffer_load_dwordx4 v3, s[40:43], s32 offen offset:1024 sc1 lds
buffer_load_dwordx4 v3, s[40:43], s32 offen offset:2048 sc1 lds
buffer_load_dwordx4 v3, s[40:43], s32 offen offset:3072 sc1 lds
s_add_u32 m0, s31, 132096
s_add_u32 s32, s32, 4096
buffer_load_dwordx4 v3, s[40:43], s32 offen sc1 lds
s_mul_i32 s31, s78, 15360
s_add_u32 m0, s31, 61440
s_add_u32 s32, s30, 40960
buffer_load_dwordx4 v3, s[40:43], s32 offen offset:0 sc1 lds
buffer_load_dwordx4 v3, s[40:43], s32 offen offset:1024 sc1 lds
buffer_load_dwordx4 v3, s[40:43], s32 offen offset:2048 sc1 lds
buffer_load_dwordx4 v3, s[40:43], s32 offen offset:3072 sc1 lds
s_add_u32 m0, s31, 65536
s_add_u32 s32, s32, 4096
buffer_load_dwordx4 v3, s[40:43], s32 offen sc1 lds
s_add_u32 m0, s31, 66560
s_add_u32 s32, s30, 61440
buffer_load_dwordx4 v3, s[40:43], s32 offen offset:0 sc1 lds
buffer_load_dwordx4 v3, s[40:43], s32 offen offset:1024 sc1 lds
buffer_load_dwordx4 v3, s[40:43], s32 offen offset:2048 sc1 lds
buffer_load_dwordx4 v3, s[40:43], s32 offen offset:3072 sc1 lds
s_add_u32 m0, s31, 70656
s_add_u32 s32, s32, 4096
buffer_load_dwordx4 v3, s[40:43], s32 offen sc1 lds
s_add_u32 m0, s31, 71680
s_add_u32 s32, s30, 81920
buffer_load_dwordx4 v3, s[40:43], s32 offen offset:0 sc1 lds
buffer_load_dwordx4 v3, s[40:43], s32 offen offset:1024 sc1 lds
buffer_load_dwordx4 v3, s[40:43], s32 offen offset:2048 sc1 lds
buffer_load_dwordx4 v3, s[40:43], s32 offen offset:3072 sc1 lds
s_add_u32 m0, s31, 75776
s_add_u32 s32, s32, 4096
buffer_load_dwordx4 v3, s[40:43], s32 offen sc1 lds
LX2:
s_and_b32 s32, s78, 1
s_lshr_b32 s33, s78, 1
s_lshl_b32 s33, s33, 21
s_add_u32 s33, s33, 17825792
s_lshl1_add_u32 s35, s61, s32
s_mul_i32 s35, s35, 61440
s_add_u32 s80, s35, s33
s_add_u32 s81, s80, 20480
s_add_u32 s82, s81, 20480
s_mul_i32 s83, s78, 6144
v_cmp_le_u32 vcc, 24, v0
v_mov_b32 v14, 5760
s_nop 0
v_cndmask_b32 v14, 0, v14, vcc
v_add_u32 v14, v14, v3
s_mul_i32 s35, s61, 384
s_add_u32 s35, s35, 3276800
s_lshl2_add_u32 s36, s60, s78
s_lshl_b32 s37, s36, 11
s_add_u32 s37, s37, 3407872
s_mul_i32 s62, s36, 40960
s_add_u32 s62, s62, 4194304
s_add_u32 s63, s62, 20480
s_lshl_b32 s65, s78, 12
s_mul_i32 s66, s28, 245760
s_mul_i32 s32, s78, 12288
s_add_u32 s66, s66, s32
s_add_u32 s66, s66, 22024192
s_lshl_b32 s54, s60, 7
s_add_u32 s54, s54, 3673088
s_mov_b32 s52, 0x3acccccd
s_waitcnt vmcnt(0)
s_barrier
v_mov_b32 v17, 0
s_mov_b32 s75, 0
LXw:
global_load_dword v16, v17, s[20:21] offset:4 sc1
s_waitcnt vmcnt(0)
LXwc:
v_cmp_gt_u32 vcc, 64, v16
s_add_u32 s75, s75, 1
s_cmp_ge_u32 s75, 0x8000
s_cbranch_scc1 LXwd
s_nop 1
s_cbranch_vccnz LXw
LXwd:
s_add_u32 s67, s66, 49152
s_add_u32 s68, s66, 98304
s_add_u32 s69, s66, 147456
s_add_u32 s70, s66, 196608
buffer_load_dwordx4 v[176:179], v14, s[40:43], s35 offen sc1
s_add_u32 s35, s35, 12288
buffer_load_dwordx4 v[180:183], v14, s[40:43], s35 offen sc1
s_add_u32 s35, s35, 12288
buffer_load_dwordx4 v[184:187], v14, s[40:43], s35 offen sc1
s_add_u32 s35, s35, 12288
buffer_load_dwordx4 v[188:191], v14, s[40:43], s35 offen sc1
s_add_u32 s35, s35, 12288
buffer_load_dwordx4 v[192:195], v14, s[40:43], s35 offen sc1
s_add_u32 s35, s35, 12288
buffer_load_dwordx4 v[16:19], v3, s[40:43], s66 offen offset:0 sc1
buffer_load_dwordx4 v[20:23], v3, s[40:43], s67 offen offset:0 sc1
buffer_load_dwordx4 v[24:27], v3, s[40:43], s68 offen offset:0 sc1
buffer_load_dwordx4 v[28:31], v3, s[40:43], s69 offen offset:0 sc1
buffer_load_dwordx4 v[32:35], v3, s[40:43], s70 offen offset:0 sc1
buffer_load_dwordx4 v[36:39], v3, s[40:43], s66 offen offset:1024 sc1
buffer_load_dwordx4 v[40:43], v3, s[40:43], s67 offen offset:1024 sc1
buffer_load_dwordx4 v[44:47], v3, s[40:43], s68 offen offset:1024 sc1
buffer_load_dwordx4 v[48:51], v3, s[40:43], s69 offen offset:1024 sc1
buffer_load_dwordx4 v[52:55], v3, s[40:43], s70 offen offset:1024 sc1
buffer_load_dwordx4 v[56:59], v3, s[40:43], s66 offen offset:2048 sc1
buffer_load_dwordx4 v[60:63], v3, s[40:43], s67 offen offset:2048 sc1
buffer_load_dwordx4 v[64:67], v3, s[40:43], s68 offen offset:2048 sc1
buffer_load_dwordx4 v[68:71], v3, s[40:43], s69 offen offset:2048 sc1
buffer_load_dwordx4 v[72:75], v3, s[40:43], s70 offen offset:2048 sc1
buffer_load_dwordx4 v[76:79], v3, s[40:43], s66 offen offset:3072 sc1
s_add_u32 s66, s66, 4096
buffer_load_dwordx4 v[80:83], v3, s[40:43], s67 offen offset:3072 sc1
s_add_u32 s67, s67, 4096
buffer_load_dwordx4 v[84:87], v3, s[40:43], s68 offen offset:3072 sc1
s_add_u32 s68, s68, 4096
buffer_load_dwordx4 v[88:91], v3, s[40:43], s69 offen offset:3072 sc1
s_add_u32 s69, s69, 4096
buffer_load_dwordx4 v[92:95], v3, s[40:43], s70 offen offset:3072 sc1
s_add_u32 s70, s70, 4096
buffer_load_dwordx4 v[96:99], v3, s[40:43], s66 offen offset:0 sc1
buffer_load_dwordx4 v[100:103], v3, s[40:43], s67 offen offset:0 sc1
buffer_load_dwordx4 v[104:107], v3, s[40:43], s68 offen offset:0 sc1
buffer_load_dwordx4 v[108:111], v3, s[40:43], s69 offen offset:0 sc1
buffer_load_dwordx4 v[112:115], v3, s[40:43], s70 offen offset:0 sc1
s_mov_b64 exec, 0
s_cmp_eq_u32 s78, 0
s_cbranch_scc1 Ldt40
s_cmp_eq_u32 s78, 1
s_cbranch_scc1 Ldt41
s_cmp_eq_u32 s78, 2
s_cbranch_scc1 Ldt42
s_branch Ldt43
Ldr4:
s_mov_b64 exec, -1
s_barrier
s_add_u32 m0, s83, 98304
s_nop 0
buffer_load_dwordx4 v3, s[40:43], s80 offen sc1 lds
buffer_load_dwordx4 v3, s[40:43], s80 offen offset:1024 sc1 lds
s_add_u32 s80, s80, 2048
s_add_u32 m0, s83, 100352
s_nop 0
buffer_load_dwordx4 v3, s[40:43], s81 offen sc1 lds
buffer_load_dwordx4 v3, s[40:43], s81 offen offset:1024 sc1 lds
s_add_u32 s81, s81, 2048
s_add_u32 m0, s83, 102400
s_nop 0
buffer_load_dwordx4 v3, s[40:43], s82 offen sc1 lds
buffer_load_dwordx4 v3, s[40:43], s82 offen offset:1024 sc1 lds
s_add_u32 s82, s82, 2048
s_add_u32 m0, s83, 139264
s_nop 0
buffer_load_dwordx4 v3, s[40:43], s80 offen sc1 lds
buffer_load_dwordx4 v3, s[40:43], s80 offen offset:1024 sc1 lds
s_add_u32 s80, s80, 2048
s_add_u32 m0, s83, 141312
s_nop 0
buffer_load_dwordx4 v3, s[40:43], s81 offen sc1 lds
buffer_load_dwordx4 v3, s[40:43], s81 offen offset:1024 sc1 lds
s_add_u32 s81, s81, 2048
s_add_u32 m0, s83, 143360
s_nop 0
buffer_load_dwordx4 v3, s[40:43], s82 offen sc1 lds
buffer_load_dwordx4 v3, s[40:43], s82 offen offset:1024 sc1 lds
s_add_u32 s82, s82, 2048
v_mov_b32 v5, 0
s_barrier
s_cmp_lg_u32 s78, 0
s_cbranch_scc1 LXa
v_mov_b32 v4, 1
s_mov_b64 exec, 1
buffer_atomic_add v4, v5, s[40:43], s54 offen
s_mov_b64 exec, -1
LXa:
s_cmp_lg_u32 s78, 0
s_cbranch_scc1 LXhd
s_mov_b32 s75, 0
LXh:
buffer_load_dword v4, v5, s[40:43], s54 offen sc1
s_waitcnt vmcnt(0)
LXhc:
v_cmp_gt_u32 vcc, 16, v4
s_add_u32 s75, s75, 1
s_cmp_ge_u32 s75, 0x8000
s_cbranch_scc1 LXhd
s_nop 1
s_cbranch_vccnz LXh
LXhd:
s_waitcnt vmcnt(1)
s_barrier
s_add_u32 m0, s65, 81920
s_nop 0
buffer_load_dwordx4 v3, s[40:43], s62 offen sc1 lds
buffer_load_dwordx4 v3, s[40:43], s62 offen offset:1024 sc1 lds
s_add_u32 s62, s62, 2048
s_add_u32 m0, s65, 83968
s_nop 0
buffer_load_dwordx4 v3, s[40:43], s63 offen sc1 lds
buffer_load_dwordx4 v3, s[40:43], s63 offen offset:1024 sc1 lds
s_add_u32 s63, s63, 2048
s_add_u32 m0, s65, 122880
s_nop 0
buffer_load_dwordx4 v3, s[40:43], s62 offen sc1 lds
buffer_load_dwordx4 v3, s[40:43], s62 offen offset:1024 sc1 lds
s_add_u32 s62, s62, 2048
s_add_u32 m0, s65, 124928
s_nop 0
buffer_load_dwordx4 v3, s[40:43], s63 offen sc1 lds
buffer_load_dwordx4 v3, s[40:43], s63 offen offset:1024 sc1 lds
s_add_u32 s63, s63, 2048
v_pk_add_f32 v[176:177], v[176:177], v[180:181]
v_pk_add_f32 v[178:179], v[178:179], v[182:183]
v_pk_add_f32 v[176:177], v[176:177], v[184:185]
v_pk_add_f32 v[178:179], v[178:179], v[186:187]
v_pk_add_f32 v[176:177], v[176:177], v[188:189]
v_pk_add_f32 v[178:179], v[178:179], v[190:191]
v_pk_add_f32 v[176:177], v[176:177], v[192:193]
v_pk_add_f32 v[178:179], v[178:179], v[194:195]
buffer_load_dwordx4 v[4:7], v3, s[40:43], s37 offen sc1
buffer_load_dwordx4 v[8:11], v3, s[40:43], s37 offen offset:1024 sc1
ds_write_b128 v3, v[176:179]
s_lshl_b32 s32, s78, 8
v_lshl_add_u32 v14, v2, 3, s32
s_add_u32 s54, s54, 2048
s_waitcnt vmcnt(6) lgkmcnt(0)
s_barrier
s_add_u32 m0, s65, 40960
s_nop 0
buffer_load_dwordx4 v3, s[40:43], s62 offen sc1 lds
buffer_load_dwordx4 v3, s[40:43], s62 offen offset:1024 sc1 lds
s_add_u32 s62, s62, 2048
s_add_u32 m0, s65, 43008
s_nop 0
buffer_load_dwordx4 v3, s[40:43], s63 offen sc1 lds
buffer_load_dwordx4 v3, s[40:43], s63 offen offset:1024 sc1 lds
s_add_u32 s63, s63, 2048
s_add_u32 m0, s83, 57344
s_nop 0
buffer_load_dwordx4 v3, s[40:43], s80 offen sc1 lds
buffer_load_dwordx4 v3, s[40:43], s80 offen offset:1024 sc1 lds
s_add_u32 s80, s80, 2048
s_add_u32 m0, s83, 59392
s_nop 0
buffer_load_dwordx4 v3, s[40:43], s81 offen sc1 lds
buffer_load_dwordx4 v3, s[40:43], s81 offen offset:1024 sc1 lds
s_add_u32 s81, s81, 2048
s_add_u32 m0, s83, 61440
s_nop 0
buffer_load_dwordx4 v3, s[40:43], s82 offen sc1 lds
buffer_load_dwordx4 v3, s[40:43], s82 offen offset:1024 sc1 lds
s_add_u32 s82, s82, 2048
s_waitcnt vmcnt(12) lgkmcnt(0)
s_barrier
s_add_u32 m0, s65, 81920
s_nop 0
buffer_load_dwordx4 v3, s[40:43], s62 offen sc1 lds
buffer_load_dwordx4 v3, s[40:43], s62 offen offset:1024 sc1 lds
s_add_u32 s62, s62, 2048
s_add_u32 m0, s65, 83968
s_nop 0
buffer_load_dwordx4 v3, s[40:43], s63 offen sc1 lds
buffer_load_dwordx4 v3, s[40:43], s63 offen offset:1024 sc1 lds
s_add_u32 s63, s63, 2048
s_add_u32 m0, s83, 98304
s_nop 0
buffer_load_dwordx4 v3, s[40:43], s80 offen sc1 lds
buffer_load_dwordx4 v3, s[40:43], s80 offen offset:1024 sc1 lds
s_add_u32 s80, s80, 2048
s_add_u32 m0, s83, 100352
s_nop 0
buffer_load_dwordx4 v3, s[40:43], s81 offen sc1 lds
buffer_load_dwordx4 v3, s[40:43], s81 offen offset:1024 sc1 lds
s_add_u32 s81, s81, 2048
s_add_u32 m0, s83, 102400
s_nop 0
buffer_load_dwordx4 v3, s[40:43], s82 offen sc1 lds
buffer_load_dwordx4 v3, s[40:43], s82 offen offset:1024 sc1 lds
s_add_u32 s82, s82, 2048
s_waitcnt vmcnt(10) lgkmcnt(0)
s_barrier
s_add_u32 m0, s65, 122880
s_nop 0
buffer_load_dwordx4 v3, s[40:43], s62 offen sc1 lds
buffer_load_dwordx4 v3, s[40:43], s62 offen offset:1024 sc1 lds
s_add_u32 s62, s62, 2048
s_add_u32 m0, s65, 124928
s_nop 0
buffer_load_dwordx4 v3, s[40:43], s63 offen sc1 lds
buffer_load_dwordx4 v3, s[40:43], s63 offen offset:1024 sc1 lds
s_add_u32 s63, s63, 2048
s_add_u32 m0, s83, 139264
s_nop 0
buffer_load_dwordx4 v3, s[40:43], s80 offen sc1 lds
buffer_load_dwordx4 v3, s[40:43], s80 offen offset:1024 sc1 lds
s_add_u32 s80, s80, 2048
s_add_u32 m0, s83, 141312
s_nop 0
buffer_load_dwordx4 v3, s[40:43], s81 offen sc1 lds
buffer_load_dwordx4 v3, s[40:43], s81 offen offset:1024 sc1 lds
s_add_u32 s81, s81, 2048
s_add_u32 m0, s83, 143360
s_nop 0
buffer_load_dwordx4 v3, s[40:43], s82 offen sc1 lds
buffer_load_dwordx4 v3, s[40:43], s82 offen offset:1024 sc1 lds
s_add_u32 s82, s82, 2048
v_pk_add_f32 v[4:5], v[4:5], v[6:7]
v_mov_b32 v6, v4
s_nop 1
v_permlane32_swap_b32 v4, v6
v_add_f32 v4, v4, v6
v_mov_b32 v6, v4
s_nop 1
v_permlane16_swap_b32 v4, v6
v_add_f32 v4, v4, v6
v_mov_b32 v7, v5
s_nop 1
v_permlane32_swap_b32 v5, v7
v_add_f32 v5, v5, v7
v_mov_b32 v7, v5
s_nop 1
v_permlane16_swap_b32 v5, v7
v_add_f32 v5, v5, v7
v_mul_f32 v4, s52, v4
v_mul_f32 v5, s52, v5
v_fma_f32 v5, -v4, v4, v5
v_max_f32 v5, 0, v5
v_add_f32 v5, 0x3727c5ac, v5
v_rcp_f32 v5, v5
v_xor_b32 v4, 0x80000000, v4
ds_write_b64 v14, v[4:5] offset:1024
v_pk_add_f32 v[8:9], v[8:9], v[10:11]
v_mov_b32 v10, v8
s_nop 1
v_permlane32_swap_b32 v8, v10
v_add_f32 v8, v8, v10
v_mov_b32 v10, v8
s_nop 1
v_permlane16_swap_b32 v8, v10
v_add_f32 v8, v8, v10
v_mov_b32 v11, v9
s_nop 1
v_permlane32_swap_b32 v9, v11
v_add_f32 v9, v9, v11
v_mov_b32 v11, v9
s_nop 1
v_permlane16_swap_b32 v9, v11
v_add_f32 v9, v9, v11
v_mul_f32 v8, s52, v8
v_mul_f32 v9, s52, v9
v_fma_f32 v9, -v8, v8, v9
v_max_f32 v9, 0, v9
v_add_f32 v9, 0x3727c5ac, v9
v_rcp_f32 v9, v9
v_xor_b32 v8, 0x80000000, v8
ds_write_b64 v14, v[8:9] offset:1152
s_waitcnt vmcnt(10) lgkmcnt(0)
s_barrier
s_add_u32 m0, s65, 40960
s_nop 0
buffer_load_dwordx4 v3, s[40:43], s62 offen sc1 lds
buffer_load_dwordx4 v3, s[40:43], s62 offen offset:1024 sc1 lds
s_add_u32 s62, s62, 2048
s_add_u32 m0, s65, 43008
s_nop 0
buffer_load_dwordx4 v3, s[40:43], s63 offen sc1 lds
buffer_load_dwordx4 v3, s[40:43], s63 offen offset:1024 sc1 lds
s_add_u32 s63, s63, 2048
s_add_u32 m0, s83, 57344
s_nop 0
buffer_load_dwordx4 v3, s[40:43], s80 offen sc1 lds
buffer_load_dwordx4 v3, s[40:43], s80 offen offset:1024 sc1 lds
s_add_u32 s80, s80, 2048
s_add_u32 m0, s83, 59392
s_nop 0
buffer_load_dwordx4 v3, s[40:43], s81 offen sc1 lds
buffer_load_dwordx4 v3, s[40:43], s81 offen offset:1024 sc1 lds
s_add_u32 s81, s81, 2048
s_add_u32 m0, s83, 61440
s_nop 0
buffer_load_dwordx4 v3, s[40:43], s82 offen sc1 lds
buffer_load_dwordx4 v3, s[40:43], s82 offen offset:1024 sc1 lds
s_add_u32 s82, s82, 2048
s_waitcnt vmcnt(10) lgkmcnt(0)
s_barrier
s_add_u32 m0, s65, 81920
s_nop 0
buffer_load_dwordx4 v3, s[40:43], s62 offen sc1 lds
buffer_load_dwordx4 v3, s[40:43], s62 offen offset:1024 sc1 lds
s_add_u32 s62, s62, 2048
s_add_u32 m0, s65, 83968
s_nop 0
buffer_load_dwordx4 v3, s[40:43], s63 offen sc1 lds
buffer_load_dwordx4 v3, s[40:43], s63 offen offset:1024 sc1 lds
s_add_u32 s63, s63, 2048
s_add_u32 m0, s83, 98304
s_nop 0
buffer_load_dwordx4 v3, s[40:43], s80 offen sc1 lds
buffer_load_dwordx4 v3, s[40:43], s80 offen offset:1024 sc1 lds
s_add_u32 s80, s80, 2048
s_add_u32 m0, s83, 100352
s_nop 0
buffer_load_dwordx4 v3, s[40:43], s81 offen sc1 lds
buffer_load_dwordx4 v3, s[40:43], s81 offen offset:1024 sc1 lds
s_add_u32 s81, s81, 2048
s_add_u32 m0, s83, 102400
s_nop 0
buffer_load_dwordx4 v3, s[40:43], s82 offen sc1 lds
buffer_load_dwordx4 v3, s[40:43], s82 offen offset:1024 sc1 lds
s_add_u32 s82, s82, 2048
s_waitcnt vmcnt(10) lgkmcnt(0)
s_barrier
s_add_u32 m0, s65, 122880
s_nop 0
buffer_load_dwordx4 v3, s[40:43], s62 offen sc1 lds
buffer_load_dwordx4 v3, s[40:43], s62 offen offset:1024 sc1 lds
s_add_u32 s62, s62, 2048
s_add_u32 m0, s65, 124928
s_nop 0
buffer_load_dwordx4 v3, s[40:43], s63 offen sc1 lds
buffer_load_dwordx4 v3, s[40:43], s63 offen offset:1024 sc1 lds
s_add_u32 s63, s63, 2048
s_add_u32 m0, s83, 139264
s_nop 0
buffer_load_dwordx4 v3, s[40:43], s80 offen sc1 lds
buffer_load_dwordx4 v3, s[40:43], s80 offen offset:1024 sc1 lds
s_add_u32 s80, s80, 2048
s_add_u32 m0, s83, 141312
s_nop 0
buffer_load_dwordx4 v3, s[40:43], s81 offen sc1 lds
buffer_load_dwordx4 v3, s[40:43], s81 offen offset:1024 sc1 lds
s_add_u32 s81, s81, 2048
s_add_u32 m0, s83, 143360
s_nop 0
buffer_load_dwordx4 v3, s[40:43], s82 offen sc1 lds
buffer_load_dwordx4 v3, s[40:43], s82 offen offset:1024 sc1 lds
s_add_u32 s82, s82, 2048
s_waitcnt vmcnt(10) lgkmcnt(0)
s_barrier
s_add_u32 m0, s65, 40960
s_nop 0
buffer_load_dwordx4 v3, s[40:43], s62 offen sc1 lds
buffer_load_dwordx4 v3, s[40:43], s62 offen offset:1024 sc1 lds
s_add_u32 s62, s62, 2048
s_add_u32 m0, s65, 43008
s_nop 0
buffer_load_dwordx4 v3, s[40:43], s63 offen sc1 lds
buffer_load_dwordx4 v3, s[40:43], s63 offen offset:1024 sc1 lds
s_add_u32 s63, s63, 2048
s_add_u32 m0, s83, 57344
s_nop 0
buffer_load_dwordx4 v3, s[40:43], s80 offen sc1 lds
buffer_load_dwordx4 v3, s[40:43], s80 offen offset:1024 sc1 lds
s_add_u32 s80, s80, 2048
s_add_u32 m0, s83, 59392
s_nop 0
buffer_load_dwordx4 v3, s[40:43], s81 offen sc1 lds
buffer_load_dwordx4 v3, s[40:43], s81 offen offset:1024 sc1 lds
s_add_u32 s81, s81, 2048
s_add_u32 m0, s83, 61440
s_nop 0
buffer_load_dwordx4 v3, s[40:43], s82 offen sc1 lds
buffer_load_dwordx4 v3, s[40:43], s82 offen offset:1024 sc1 lds
s_add_u32 s82, s82, 2048
s_waitcnt vmcnt(10) lgkmcnt(0)
s_barrier
s_add_u32 m0, s65, 81920
s_nop 0
buffer_load_dwordx4 v3, s[40:43], s62 offen sc1 lds
buffer_load_dwordx4 v3, s[40:43], s62 offen offset:1024 sc1 lds
s_add_u32 s62, s62, 2048
s_add_u32 m0, s65, 83968
s_nop 0
buffer_load_dwordx4 v3, s[40:43], s63 offen sc1 lds
buffer_load_dwordx4 v3, s[40:43], s63 offen offset:1024 sc1 lds
s_add_u32 s63, s63, 2048
s_add_u32 m0, s83, 98304
s_nop 0
buffer_load_dwordx4 v3, s[40:43], s80 offen sc1 lds
buffer_load_dwordx4 v3, s[40:43], s80 offen offset:1024 sc1 lds
s_add_u32 s80, s80, 2048
s_add_u32 m0, s83, 100352
s_nop 0
buffer_load_dwordx4 v3, s[40:43], s81 offen sc1 lds
buffer_load_dwordx4 v3, s[40:43], s81 offen offset:1024 sc1 lds
s_add_u32 s81, s81, 2048
s_add_u32 m0, s83, 102400
s_nop 0
buffer_load_dwordx4 v3, s[40:43], s82 offen sc1 lds
buffer_load_dwordx4 v3, s[40:43], s82 offen offset:1024 sc1 lds
s_add_u32 s82, s82, 2048
s_waitcnt vmcnt(10) lgkmcnt(0)
s_barrier
buffer_load_dwordx4 v[116:119], v3, s[40:43], s66 offen offset:1024 sc1
buffer_load_dwordx4 v[120:123], v3, s[40:43], s67 offen offset:1024 sc1
buffer_load_dwordx4 v[124:127], v3, s[40:43], s68 offen offset:1024 sc1
buffer_load_dwordx4 v[128:131], v3, s[40:43], s69 offen offset:1024 sc1
buffer_load_dwordx4 v[132:135], v3, s[40:43], s70 offen offset:1024 sc1
buffer_load_dwordx4 v[136:139], v3, s[40:43], s66 offen offset:2048 sc1
buffer_load_dwordx4 v[140:143], v3, s[40:43], s67 offen offset:2048 sc1
buffer_load_dwordx4 v[144:147], v3, s[40:43], s68 offen offset:2048 sc1
buffer_load_dwordx4 v[148:151], v3, s[40:43], s69 offen offset:2048 sc1
buffer_load_dwordx4 v[152:155], v3, s[40:43], s70 offen offset:2048 sc1
s_waitcnt vmcnt(10) lgkmcnt(0)
s_barrier
buffer_load_dwordx4 v[156:159], v3, s[40:43], s66 offen offset:3072 sc1
buffer_load_dwordx4 v[160:163], v3, s[40:43], s67 offen offset:3072 sc1
buffer_load_dwordx4 v[164:167], v3, s[40:43], s68 offen offset:3072 sc1
buffer_load_dwordx4 v[168:171], v3, s[40:43], s69 offen offset:3072 sc1
buffer_load_dwordx4 v[172:175], v3, s[40:43], s70 offen offset:3072 sc1
s_mul_i32 s32, s78, 40960
v_add_u32 v12, s32, v3
v_mov_b32 v5, 0
s_barrier
ds_write_b128 v12, v[16:19] offset:20480
ds_write_b128 v12, v[20:23] offset:21504
ds_write_b128 v12, v[24:27] offset:22528
ds_write_b128 v12, v[28:31] offset:23552
ds_write_b128 v12, v[32:35] offset:24576
ds_write_b128 v12, v[36:39] offset:25600
ds_write_b128 v12, v[40:43] offset:26624
ds_write_b128 v12, v[44:47] offset:27648
ds_write_b128 v12, v[48:51] offset:28672
ds_write_b128 v12, v[52:55] offset:29696
ds_write_b128 v12, v[56:59] offset:30720
ds_write_b128 v12, v[60:63] offset:31744
ds_write_b128 v12, v[64:67] offset:32768
ds_write_b128 v12, v[68:71] offset:33792
ds_write_b128 v12, v[72:75] offset:34816
ds_write_b128 v12, v[76:79] offset:35840
ds_write_b128 v12, v[80:83] offset:36864
ds_write_b128 v12, v[84:87] offset:37888
ds_write_b128 v12, v[88:91] offset:38912
ds_write_b128 v12, v[92:95] offset:39936
v_and_b32 v6, 31, v0
v_min_u32 v6, 23, v6
v_lshlrev_b32 v6, 7, v6
v_lshrrev_b32 v7, 5, v0
v_mul_u32_u24 v7, 49152, v7
v_add_u32 v6, v6, v7
s_mul_i32 s32, s36, 96
s_mul_i32 s33, s61, 3
s_add_u32 s32, s32, s33
s_lshl_b32 s32, s32, 10
s_add_u32 s32, s32, 8388608
s_and_b32 s33, s26, 3
s_lshl2_add_u32 s33, s27, s33
s_lshl2_add_u32 s33, s33, s78
s_mul_i32 s33, s33, 12288
s_add_u32 s33, s33, 8392704
v_lshlrev_b32 v7, 7, v0
s_barrier
s_cmp_lg_u32 s78, 0
s_cbranch_scc1 LXb
v_mov_b32 v4, 1
s_mov_b64 exec, 1
buffer_atomic_add v4, v5, s[40:43], s54 offen
s_mov_b64 exec, -1
LXb:
s_waitcnt vmcnt(1)
ds_write_b128 v12, v[96:99] offset:0
ds_write_b128 v12, v[100:103] offset:1024
ds_write_b128 v12, v[104:107] offset:2048
ds_write_b128 v12, v[108:111] offset:3072
ds_write_b128 v12, v[112:115] offset:4096
ds_write_b128 v12, v[116:119] offset:5120
ds_write_b128 v12, v[120:123] offset:6144
ds_write_b128 v12, v[124:127] offset:7168
ds_write_b128 v12, v[128:131] offset:8192
ds_write_b128 v12, v[132:135] offset:9216
ds_write_b128 v12, v[136:139] offset:10240
ds_write_b128 v12, v[140:143] offset:11264
ds_write_b128 v12, v[144:147] offset:12288
ds_write_b128 v12, v[148:151] offset:13312
ds_write_b128 v12, v[152:155] offset:14336
ds_write_b128 v12, v[156:159] offset:15360
ds_write_b128 v12, v[160:163] offset:16384
ds_write_b128 v12, v[164:167] offset:17408
ds_write_b128 v12, v[168:171] offset:18432
s_cmp_lg_u32 s78, 0
s_cbranch_scc1 LXgd
s_mov_b32 s75, 0
LXg:
buffer_load_dword v4, v5, s[40:43], s54 offen sc1
s_waitcnt vmcnt(0)
LXgc:
v_cmp_gt_u32 vcc, 16, v4
s_add_u32 s75, s75, 1
s_cmp_ge_u32 s75, 0x8000
s_cbranch_scc1 LXgd
s_nop 1
s_cbranch_vccnz LXg
LXgd:
s_waitcnt vmcnt(0)
ds_write_b128 v12, v[172:175] offset:19456
s_waitcnt lgkmcnt(0)
s_barrier
s_waitcnt vmcnt(0)
s_endpgm
LC2b:
s_barrier
LC2:
s_lshr_b32 s27, s26, 2
s_lshl3_add_u32 s27, s76, s27
s_and_b32 s28, s26, 3
s_lshl2_add_u32 s28, s77, s28
s_lshl2_add_u32 s29, s27, s78
s_lshr_b32 s60, s27, 1
s_and_b32 s61, s26, 7
s_lshl3_add_u32 s61, s77, s61
s_mul_i32 s34, s78, 15360
s_mul_i32 s35, s78, 13440
s_add_u32 s35, s35, 3145728
s_mul_i32 s37, s78, 5120
s_add_u32 s32, s78, 0
s_and_b32 s32, s32, 3
s_lshl2_add_u32 s32, s27, s32
s_mul_i32 s33, s32, 20480
s_add_u32 s62, s33, s37
s_mul_i32 s71, s32, 49152
s_add_u32 s32, s78, 1
s_and_b32 s32, s32, 3
s_lshl2_add_u32 s32, s27, s32
s_mul_i32 s33, s32, 20480
s_add_u32 s63, s33, s37
s_mul_i32 s72, s32, 49152
s_add_u32 s32, s78, 2
s_and_b32 s32, s32, 3
s_lshl2_add_u32 s32, s27, s32
s_mul_i32 s33, s32, 20480
s_add_u32 s64, s33, s37
s_mul_i32 s73, s32, 49152
s_add_u32 s32, s78, 3
s_and_b32 s32, s32, 3
s_lshl2_add_u32 s32, s27, s32
s_mul_i32 s33, s32, 20480
s_add_u32 s65, s33, s37
s_mul_i32 s74, s32, 49152
s_add_u32 s39, s34, 14336
v_mov_b32 v14, s39
v_and_b32 v8, 3, v2
v_lshrrev_b32 v9, 2, v2
v_lshl_add_u32 v8, v8, 2, v9
v_add_u32 v9, 0, v8
v_mul_u32_u24 v9, 52, v9
v_lshrrev_b32 v5, 8, v9
v_add_u32 v9, 12, v8
v_mul_u32_u24 v9, 52, v9
v_lshrrev_b32 v6, 8, v9
v_add_u32 v9, 28, v8
v_mul_u32_u24 v9, 52, v9
v_lshrrev_b32 v7, 8, v9
Ldp20:
v_add_u32 v8, 0, v1
v_mul_u32_u24 v9, 52, v8
v_lshrrev_b32 v9, 8, v9
v_mul_u32_u24 v10, 20, v9
v_sub_u32 v10, v2, v10
v_mul_u32_u24 v8, 336, v8
v_add_u32 v8, s34, v8
v_add_u32 v11, 320, v8
v_cmp_eq_u32 vcc, v9, v5
s_nop 1
v_cndmask_b32 v16, v14, v11, vcc
v_add_u32 v12, 0, v10
v_cmp_gt_u32 vcc, 20, v12
v_lshl_add_u32 v12, v12, 4, v8
s_nop 0
v_cndmask_b32 v44, v14, v12, vcc
v_add_u32 v12, 16, v10
v_cmp_gt_u32 vcc, 20, v12
v_lshl_add_u32 v12, v12, 4, v8
s_nop 0
v_cndmask_b32 v48, v14, v12, vcc
v_mov_b32 v56, 0
v_mov_b32 v57, 0
v_add_u32 v8, 4, v1
v_mul_u32_u24 v9, 52, v8
v_lshrrev_b32 v9, 8, v9
v_mul_u32_u24 v10, 20, v9
v_sub_u32 v10, v2, v10
v_mul_u32_u24 v8, 336, v8
v_add_u32 v8, s34, v8
v_add_u32 v11, 320, v8
v_cmp_eq_u32 vcc, v9, v5
s_nop 1
v_cndmask_b32 v18, v14, v11, vcc
v_add_u32 v12, 0, v10
v_cmp_gt_u32 vcc, 20, v12
v_lshl_add_u32 v12, v12, 4, v8
s_nop 0
v_cndmask_b32 v46, v14, v12, vcc
v_add_u32 v12, 16, v10
v_cmp_gt_u32 vcc, 20, v12
v_lshl_add_u32 v12, v12, 4, v8
s_nop 0
v_cndmask_b32 v50, v14, v12, vcc
v_add_u32 v12, 32, v10
v_cmp_gt_u32 vcc, 20, v12
v_lshl_add_u32 v12, v12, 4, v8
s_nop 0
v_cndmask_b32 v58, v14, v12, vcc
v_add_u32 v8, 8, v1
v_mul_u32_u24 v9, 52, v8
v_lshrrev_b32 v9, 8, v9
v_mul_u32_u24 v10, 20, v9
v_sub_u32 v10, v2, v10
v_mul_u32_u24 v8, 336, v8
v_add_u32 v8, s34, v8
v_add_u32 v11, 320, v8
v_cmp_eq_u32 vcc, v9, v5
s_nop 1
v_cndmask_b32 v20, v14, v11, vcc
v_cmp_eq_u32 vcc, v9, v6
s_nop 1
v_cndmask_b32 v24, v14, v11, vcc
v_add_u32 v12, 16, v10
v_cmp_gt_u32 vcc, 20, v12
v_lshl_add_u32 v12, v12, 4, v8
s_nop 0
v_cndmask_b32 v52, v14, v12, vcc
s_cbranch_execz Ldr2
Ldp21:
v_add_u32 v12, 32, v10
v_cmp_gt_u32 vcc, 20, v12
v_lshl_add_u32 v12, v12, 4, v8
s_nop 0
v_cndmask_b32 v60, v14, v12, vcc
v_add_u32 v12, 48, v10
v_cmp_gt_u32 vcc, 20, v12
v_lshl_add_u32 v12, v12, 4, v8
s_nop 0
v_cndmask_b32 v64, v14, v12, vcc
v_mov_b32 v72, 0
v_mov_b32 v73, 0
v_add_u32 v8, 12, v1
v_mul_u32_u24 v9, 52, v8
v_lshrrev_b32 v9, 8, v9
v_mul_u32_u24 v10, 20, v9
v_sub_u32 v10, v2, v10
v_mul_u32_u24 v8, 336, v8
v_add_u32 v8, s34, v8
v_add_u32 v11, 320, v8
v_cmp_eq_u32 vcc, v9, v5
s_nop 1
v_cndmask_b32 v22, v14, v11, vcc
v_cmp_eq_u32 vcc, v9, v6
s_nop 1
v_cndmask_b32 v26, v14, v11, vcc
v_mov_b32 v54, 0
v_mov_b32 v55, 0
v_add_u32 v12, 32, v10
v_cmp_gt_u32 vcc, 20, v12
v_lshl_add_u32 v12, v12, 4, v8
s_nop 0
v_cndmask_b32 v62, v14, v12, vcc
v_add_u32 v12, 48, v10
v_cmp_gt_u32 vcc, 20, v12
v_lshl_add_u32 v12, v12, 4, v8
s_nop 0
v_cndmask_b32 v66, v14, v12, vcc
v_add_u32 v12, 64, v10
v_cmp_gt_u32 vcc, 20, v12
v_lshl_add_u32 v12, v12, 4, v8
s_nop 0
v_cndmask_b32 v74, v14, v12, vcc
v_add_u32 v8, 16, v1
v_mul_u32_u24 v9, 52, v8
v_lshrrev_b32 v9, 8, v9
v_mul_u32_u24 v10, 20, v9
v_sub_u32 v10, v2, v10
v_mul_u32_u24 v8, 336, v8
v_add_u32 v8, s34, v8
v_add_u32 v11, 320, v8
v_cmp_eq_u32 vcc, v9, v6
s_nop 1
v_cndmask_b32 v28, v14, v11, vcc
v_add_u32 v12, 48, v10
v_cmp_gt_u32 vcc, 20, v12
v_lshl_add_u32 v12, v12, 4, v8
s_nop 0
v_cndmask_b32 v68, v14, v12, vcc
v_add_u32 v12, 64, v10
v_cmp_gt_u32 vcc, 20, v12
v_lshl_add_u32 v12, v12, 4, v8
s_nop 0
v_cndmask_b32 v76, v14, v12, vcc
v_mov_b32 v80, 0
v_mov_b32 v81, 0
v_mov_b32 v88, 0
v_mov_b32 v89, 0
s_cbranch_execz Ldr2
Ldp22:
v_add_u32 v8, 20, v1
v_mul_u32_u24 v9, 52, v8
v_lshrrev_b32 v9, 8, v9
v_mul_u32_u24 v10, 20, v9
v_sub_u32 v10, v2, v10
v_mul_u32_u24 v8, 336, v8
v_add_u32 v8, s34, v8
v_add_u32 v11, 320, v8
v_cmp_eq_u32 vcc, v9, v6
s_nop 1
v_cndmask_b32 v30, v14, v11, vcc
v_mov_b32 v70, 0
v_mov_b32 v71, 0
v_mov_b32 v78, 0
v_mov_b32 v79, 0
v_add_u32 v12, 80, v10
v_cmp_gt_u32 vcc, 20, v12
v_lshl_add_u32 v12, v12, 4, v8
s_nop 0
v_cndmask_b32 v82, v14, v12, vcc
v_add_u32 v12, 96, v10
v_cmp_gt_u32 vcc, 20, v12
v_lshl_add_u32 v12, v12, 4, v8
s_nop 0
v_cndmask_b32 v90, v14, v12, vcc
v_add_u32 v8, 24, v1
v_mul_u32_u24 v9, 52, v8
v_lshrrev_b32 v9, 8, v9
v_mul_u32_u24 v10, 20, v9
v_sub_u32 v10, v2, v10
v_mul_u32_u24 v8, 336, v8
v_add_u32 v8, s34, v8
v_add_u32 v11, 320, v8
v_cmp_eq_u32 vcc, v9, v6
s_nop 1
v_cndmask_b32 v32, v14, v11, vcc
v_cmp_eq_u32 vcc, v9, v7
s_nop 1
v_cndmask_b32 v36, v14, v11, vcc
v_add_u32 v12, 80, v10
v_cmp_gt_u32 vcc, 20, v12
v_lshl_add_u32 v12, v12, 4, v8
s_nop 0
v_cndmask_b32 v84, v14, v12, vcc
v_add_u32 v12, 96, v10
v_cmp_gt_u32 vcc, 20, v12
v_lshl_add_u32 v12, v12, 4, v8
s_nop 0
v_cndmask_b32 v92, v14, v12, vcc
v_add_u32 v12, 112, v10
v_cmp_gt_u32 vcc, 20, v12
v_lshl_add_u32 v12, v12, 4, v8
s_nop 0
v_cndmask_b32 v96, v14, v12, vcc
v_mov_b32 v104, 0
v_mov_b32 v105, 0
v_add_u32 v8, 28, v1
v_mul_u32_u24 v9, 52, v8
v_lshrrev_b32 v9, 8, v9
v_mul_u32_u24 v10, 20, v9
v_sub_u32 v10, v2, v10
v_mul_u32_u24 v8, 336, v8
v_add_u32 v8, s34, v8
v_add_u32 v11, 320, v8
v_cmp_eq_u32 vcc, v9, v6
s_nop 1
v_cndmask_b32 v34, v14, v11, vcc
s_cbranch_execz Ldr2
Ldp23:
v_cmp_eq_u32 vcc, v9, v7
s_nop 1
v_cndmask_b32 v38, v14, v11, vcc
v_mov_b32 v86, 0
v_mov_b32 v87, 0
v_add_u32 v12, 96, v10
v_cmp_gt_u32 vcc, 20, v12
v_lshl_add_u32 v12, v12, 4, v8
s_nop 0
v_cndmask_b32 v94, v14, v12, vcc
v_add_u32 v12, 112, v10
v_cmp_gt_u32 vcc, 20, v12
v_lshl_add_u32 v12, v12, 4, v8
s_nop 0
v_cndmask_b32 v98, v14, v12, vcc
v_add_u32 v12, 128, v10
v_cmp_gt_u32 vcc, 20, v12
v_lshl_add_u32 v12, v12, 4, v8
s_nop 0
v_cndmask_b32 v106, v14, v12, vcc
v_add_u32 v8, 32, v1
v_mul_u32_u24 v9, 52, v8
v_lshrrev_b32 v9, 8, v9
v_mul_u32_u24 v10, 20, v9
v_sub_u32 v10, v2, v10
v_mul_u32_u24 v8, 336, v8
v_add_u32 v8, s34, v8
v_add_u32 v11, 320, v8
v_cmp_eq_u32 vcc, v9, v7
s_nop 1
v_cndmask_b32 v40, v14, v11, vcc
v_add_u32 v12, 112, v10
v_cmp_gt_u32 vcc, 20, v12
v_lshl_add_u32 v12, v12, 4, v8
s_nop 0
v_cndmask_b32 v100, v14, v12, vcc
v_add_u32 v12, 128, v10
v_cmp_gt_u32 vcc, 20, v12
v_lshl_add_u32 v12, v12, 4, v8
s_nop 0
v_cndmask_b32 v108, v14, v12, vcc
v_add_u32 v12, 144, v10
v_cmp_gt_u32 vcc, 20, v12
v_lshl_add_u32 v12, v12, 4, v8
s_nop 0
v_cndmask_b32 v112, v14, v12, vcc
v_add_u32 v8, 36, v1
v_mul_u32_u24 v9, 52, v8
v_lshrrev_b32 v9, 8, v9
v_mul_u32_u24 v10, 20, v9
v_sub_u32 v10, v2, v10
v_mul_u32_u24 v8, 336, v8
v_add_u32 v8, s34, v8
v_add_u32 v11, 320, v8
v_cmp_eq_u32 vcc, v9, v7
s_nop 1
v_cndmask_b32 v42, v14, v11, vcc
v_mov_b32 v102, 0
v_mov_b32 v103, 0
v_add_u32 v12, 128, v10
v_cmp_gt_u32 vcc, 20, v12
v_lshl_add_u32 v12, v12, 4, v8
s_nop 0
v_cndmask_b32 v110, v14, v12, vcc
v_add_u32 v12, 144, v10
v_cmp_gt_u32 vcc, 20, v12
v_lshl_add_u32 v12, v12, 4, v8
s_nop 0
v_cndmask_b32 v114, v14, v12, vcc
s_cbranch_execz Ldr2
s_cmp_lt_u32 s26, 24
s_cbranch_scc1 LCnh
s_waitcnt vmcnt(0)
s_barrier
s_barrier
LCnh:
v_mov_b32 v15, 45312
v_mov_b32 v13, 1
v_mov_b32 v4, 1
v_mov_b32 v5, 0
s_waitcnt vmcnt(0)
s_mov_b64 exec, 1
ds_add_rtn_u32 v12, v15, v13
s_waitcnt lgkmcnt(0)
v_readfirstlane_b32 s81, v12
s_cmp_lg_u32 s81, 3
s_cbranch_scc1 LCna
buffer_atomic_add v4, v5, s[40:43], s54 offen sc0
LCna:
s_mov_b64 exec, -1
s_lshl_b32 s32, s60, 7
s_add_u32 s33, s32, 3671040
v_min_u32 v6, 8, v0
v_lshlrev_b32 v6, 2, v6
v_lshlrev_b32 v7, 7, v2
v_mov_b32 v12, 4
s_mov_b32 s75, 0
s_cmp_lg_u32 s81, 3
s_cbranch_scc1 LCsq
s_cmp_ge_u32 s54, 3671040
s_cbranch_scc1 LCnf
s_waitcnt vmcnt(0)
v_readfirstlane_b32 s30, v4
s_cmp_lg_u32 s30, 15
s_cbranch_scc1 LCnf
s_mov_b64 exec, 0xffff
buffer_store_dword v12, v7, s[40:43], s80 offen sc1
s_mov_b64 exec, -1
LCnf:
v_cmp_gt_u32 vcc, 8, v0
s_nop 1
v_cndmask_b32_e64 v7, 4, 0, vcc
s_mov_b32 s75, 0
LCq:
buffer_load_dword v12, v6, s[40:43], s33 offen sc1
s_waitcnt vmcnt(0)
LCqc:
v_cmp_gt_u32 vcc, v7, v12
s_add_u32 s75, s75, 1
s_cmp_ge_u32 s75, 0x8000
s_cbranch_scc1 LCqd
s_nop 1
s_cbranch_vccnz LCq
LCqd:
ds_write_b32 v15, v13 offset:4
buffer_load_dwordx4 v[176:179], v3, s[40:43], s62 offen offset:0 sc1
buffer_load_dwordx4 v[180:183], v3, s[40:43], s62 offen offset:1024 sc1
buffer_load_dwordx4 v[184:187], v3, s[40:43], s62 offen offset:2048 sc1
buffer_load_dwordx4 v[188:191], v3, s[40:43], s62 offen offset:3072 sc1
s_add_u32 s62, s62, 4096
buffer_load_dwordx4 v[192:195], v3, s[40:43], s62 offen offset:0 sc1
buffer_load_dwordx4 v[196:199], v3, s[40:43], s63 offen offset:0 sc1
buffer_load_dwordx4 v[200:203], v3, s[40:43], s63 offen offset:1024 sc1
buffer_load_dwordx4 v[204:207], v3, s[40:43], s63 offen offset:2048 sc1
buffer_load_dwordx4 v[208:211], v3, s[40:43], s63 offen offset:3072 sc1
s_add_u32 s63, s63, 4096
buffer_load_dwordx4 v[212:215], v3, s[40:43], s63 offen offset:0 sc1
buffer_load_dwordx4 v[216:219], v3, s[40:43], s64 offen offset:0 sc1
buffer_load_dwordx4 v[220:223], v3, s[40:43], s64 offen offset:1024 sc1
buffer_load_dwordx4 v[224:227], v3, s[40:43], s64 offen offset:2048 sc1
buffer_load_dwordx4 v[228:231], v3, s[40:43], s64 offen offset:3072 sc1
s_add_u32 s64, s64, 4096
buffer_load_dwordx4 v[232:235], v3, s[40:43], s64 offen offset:0 sc1
buffer_load_dwordx4 v[236:239], v3, s[40:43], s65 offen offset:0 sc1
buffer_load_dwordx4 v[240:243], v3, s[40:43], s65 offen offset:1024 sc1
buffer_load_dwordx4 v[244:247], v3, s[40:43], s65 offen offset:2048 sc1
buffer_load_dwordx4 v[248:251], v3, s[40:43], s65 offen offset:3072 sc1
s_add_u32 s65, s65, 4096
buffer_load_dwordx4 v[252:255], v3, s[40:43], s65 offen offset:0 sc1
s_mov_b32 s75, 0
s_branch LCpc
LCp:
buffer_load_dword v12, v6, s[40:43], s33 offen sc1
s_waitcnt vmcnt(0)
LCpc:
v_cmp_gt_u32 vcc, 4, v12
s_add_u32 s75, s75, 1
s_cmp_ge_u32 s75, 0x8000
s_cbranch_scc1 LCpd
s_nop 1
s_cbranch_vccnz LCp
LCpd:
v_mov_b32 v13, 2
ds_write_b32 v15, v13 offset:4
s_branch LCs2d
LCsq:
LCsp:
ds_read_b32 v12, v15 offset:4
s_add_u32 s75, s75, 1
s_waitcnt lgkmcnt(0)
v_readfirstlane_b32 s30, v12
s_cmp_ge_u32 s75, 0x100000
s_cbranch_scc1 LCspd
s_cmp_lt_u32 s30, 1
s_cbranch_scc1 LCsp
LCspd:
buffer_load_dwordx4 v[176:179], v3, s[40:43], s62 offen offset:0 sc1
buffer_load_dwordx4 v[180:183], v3, s[40:43], s62 offen offset:1024 sc1
buffer_load_dwordx4 v[184:187], v3, s[40:43], s62 offen offset:2048 sc1
buffer_load_dwordx4 v[188:191], v3, s[40:43], s62 offen offset:3072 sc1
s_add_u32 s62, s62, 4096
buffer_load_dwordx4 v[192:195], v3, s[40:43], s62 offen offset:0 sc1
buffer_load_dwordx4 v[196:199], v3, s[40:43], s63 offen offset:0 sc1
buffer_load_dwordx4 v[200:203], v3, s[40:43], s63 offen offset:1024 sc1
buffer_load_dwordx4 v[204:207], v3, s[40:43], s63 offen offset:2048 sc1
buffer_load_dwordx4 v[208:211], v3, s[40:43], s63 offen offset:3072 sc1
s_add_u32 s63, s63, 4096
buffer_load_dwordx4 v[212:215], v3, s[40:43], s63 offen offset:0 sc1
buffer_load_dwordx4 v[216:219], v3, s[40:43], s64 offen offset:0 sc1
buffer_load_dwordx4 v[220:223], v3, s[40:43], s64 offen offset:1024 sc1
buffer_load_dwordx4 v[224:227], v3, s[40:43], s64 offen offset:2048 sc1
buffer_load_dwordx4 v[228:231], v3, s[40:43], s64 offen offset:3072 sc1
s_add_u32 s64, s64, 4096
buffer_load_dwordx4 v[232:235], v3, s[40:43], s64 offen offset:0 sc1
buffer_load_dwordx4 v[236:239], v3, s[40:43], s65 offen offset:0 sc1
buffer_load_dwordx4 v[240:243], v3, s[40:43], s65 offen offset:1024 sc1
buffer_load_dwordx4 v[244:247], v3, s[40:43], s65 offen offset:2048 sc1
buffer_load_dwordx4 v[248:251], v3, s[40:43], s65 offen offset:3072 sc1
s_add_u32 s65, s65, 4096
buffer_load_dwordx4 v[252:255], v3, s[40:43], s65 offen offset:0 sc1
LCs2:
ds_read_b32 v12, v15 offset:4
s_add_u32 s75, s75, 1
s_waitcnt lgkmcnt(0)
v_readfirstlane_b32 s30, v12
s_cmp_ge_u32 s75, 0x100000
s_cbranch_scc1 LCs2d
s_cmp_lt_u32 s30, 2
s_cbranch_scc1 LCs2
LCs2d:
s_add_u32 m0, s34, 0
s_add_u32 s38, s35, 0
buffer_load_dwordx4 v3, s[40:43], s38 offen offset:0 sc1 lds
buffer_load_dwordx4 v3, s[40:43], s38 offen offset:1024 sc1 lds
buffer_load_dwordx4 v3, s[40:43], s38 offen offset:2048 sc1 lds
buffer_load_dwordx4 v3, s[40:43], s38 offen offset:3072 sc1 lds
s_add_u32 m0, s34, 4096
s_add_u32 s38, s35, 4096
buffer_load_dwordx4 v3, s[40:43], s38 offen offset:0 sc1 lds
buffer_load_dwordx4 v3, s[40:43], s38 offen offset:1024 sc1 lds
buffer_load_dwordx4 v3, s[40:43], s38 offen offset:2048 sc1 lds
buffer_load_dwordx4 v3, s[40:43], s38 offen offset:3072 sc1 lds
s_add_u32 m0, s34, 8192
s_add_u32 s38, s35, 8192
buffer_load_dwordx4 v3, s[40:43], s38 offen offset:0 sc1 lds
buffer_load_dwordx4 v3, s[40:43], s38 offen offset:1024 sc1 lds
buffer_load_dwordx4 v3, s[40:43], s38 offen offset:2048 sc1 lds
buffer_load_dwordx4 v3, s[40:43], s38 offen offset:3072 sc1 lds
s_add_u32 m0, s34, 12288
s_add_u32 s38, s35, 12288
buffer_load_dwordx4 v3, s[40:43], s38 offen offset:0 sc1 lds
buffer_load_dwordx4 v3, s[40:43], s38 offen offset:1024 sc1 lds
v_mov_b32 v8, 0
v_mov_b32 v9, 0
v_mov_b32 v10, 0
v_mov_b32 v11, 0
ds_write_b128 v14, v[8:11]
s_mov_b32 s56, s4
s_mov_b32 s57, s5
s_mov_b32 s58, 2621440
s_mov_b32 s59, 0x20000
s_mov_b32 s44, s18
s_mov_b32 s45, s19
s_mov_b32 s46, 2621440
s_mov_b32 s47, 0x20000
s_lshl3_add_u32 s66, s29, s28
s_mul_i32 s66, s66, 2560
s_add_u32 s66, s66, 4194304
v_mul_u32_u24 v14, 1280, v2
v_lshl_add_u32 v14, v1, 3, v14
s_mul_i32 s79, s29, 20480
s_mul_i32 s31, s28, 160
s_add_u32 s79, s79, s31
s_add_u32 s31, s34, 61440
v_add_u32 v15, s31, v3
s_mul_i32 s31, s78, 10240
s_add_u32 s31, s31, 122880
s_waitcnt vmcnt(0)
s_barrier
ds_read_b128 v[116:119], v16
ds_read_b128 v[120:123], v18
ds_read_b128 v[124:127], v20
ds_read_b128 v[128:131], v22
ds_read_b128 v[132:135], v24
ds_read_b128 v[136:139], v26
ds_read_b128 v[140:143], v28
ds_read_b128 v[144:147], v30
ds_read_b128 v[148:151], v32
ds_read_b128 v[152:155], v34
ds_read_b128 v[156:159], v36
ds_read_b128 v[160:163], v38
ds_read_b128 v[164:167], v40
s_waitcnt lgkmcnt(12)
v_cvt_pk_bf16_f32 v16, v116, v117
v_cvt_pk_bf16_f32 v17, v118, v119
ds_read_b128 v[116:119], v42
s_waitcnt lgkmcnt(12)
v_cvt_pk_bf16_f32 v18, v120, v121
v_cvt_pk_bf16_f32 v19, v122, v123
ds_read_b128 v[120:123], v44
s_waitcnt lgkmcnt(12)
v_cvt_pk_bf16_f32 v20, v124, v125
v_cvt_pk_bf16_f32 v21, v126, v127
ds_read_b128 v[124:127], v46
s_waitcnt lgkmcnt(12)
v_cvt_pk_bf16_f32 v22, v128, v129
v_cvt_pk_bf16_f32 v23, v130, v131
ds_read_b128 v[128:131], v48
s_waitcnt lgkmcnt(12)
v_cvt_pk_bf16_f32 v24, v132, v133
v_cvt_pk_bf16_f32 v25, v134, v135
ds_read_b128 v[132:135], v50
s_waitcnt lgkmcnt(12)
v_cvt_pk_bf16_f32 v26, v136, v137
v_cvt_pk_bf16_f32 v27, v138, v139
ds_read_b128 v[136:139], v52
s_waitcnt lgkmcnt(12)
v_cvt_pk_bf16_f32 v28, v140, v141
v_cvt_pk_bf16_f32 v29, v142, v143
ds_read_b128 v[140:143], v58
s_waitcnt lgkmcnt(12)
v_cvt_pk_bf16_f32 v30, v144, v145
v_cvt_pk_bf16_f32 v31, v146, v147
ds_read_b128 v[144:147], v60
s_waitcnt lgkmcnt(12)
v_cvt_pk_bf16_f32 v32, v148, v149
v_cvt_pk_bf16_f32 v33, v150, v151
ds_read_b128 v[148:151], v62
s_waitcnt lgkmcnt(12)
v_cvt_pk_bf16_f32 v34, v152, v153
v_cvt_pk_bf16_f32 v35, v154, v155
ds_read_b128 v[152:155], v64
s_waitcnt lgkmcnt(12)
v_cvt_pk_bf16_f32 v36, v156, v157
v_cvt_pk_bf16_f32 v37, v158, v159
ds_read_b128 v[156:159], v66
s_waitcnt lgkmcnt(12)
v_cvt_pk_bf16_f32 v38, v160, v161
v_cvt_pk_bf16_f32 v39, v162, v163
ds_read_b128 v[160:163], v68
s_waitcnt lgkmcnt(12)
v_cvt_pk_bf16_f32 v40, v164, v165
v_cvt_pk_bf16_f32 v41, v166, v167
ds_read_b128 v[164:167], v74
s_waitcnt lgkmcnt(12)
v_cvt_pk_bf16_f32 v42, v116, v117
v_cvt_pk_bf16_f32 v43, v118, v119
ds_read_b128 v[116:119], v76
s_waitcnt lgkmcnt(12)
v_cvt_pk_bf16_f32 v44, v120, v121
v_cvt_pk_bf16_f32 v45, v122, v123
ds_read_b128 v[120:123], v82
s_waitcnt lgkmcnt(12)
v_cvt_pk_bf16_f32 v46, v124, v125
v_cvt_pk_bf16_f32 v47, v126, v127
ds_read_b128 v[124:127], v84
s_waitcnt lgkmcnt(12)
v_cvt_pk_bf16_f32 v48, v128, v129
v_cvt_pk_bf16_f32 v49, v130, v131
ds_read_b128 v[128:131], v90
s_waitcnt lgkmcnt(12)
v_cvt_pk_bf16_f32 v50, v132, v133
v_cvt_pk_bf16_f32 v51, v134, v135
ds_read_b128 v[132:135], v92
s_waitcnt lgkmcnt(12)
v_cvt_pk_bf16_f32 v52, v136, v137
v_cvt_pk_bf16_f32 v53, v138, v139
ds_read_b128 v[136:139], v94
s_waitcnt lgkmcnt(12)
v_cvt_pk_bf16_f32 v58, v140, v141
v_cvt_pk_bf16_f32 v59, v142, v143
ds_read_b128 v[140:143], v96
s_waitcnt lgkmcnt(12)
v_cvt_pk_bf16_f32 v60, v144, v145
v_cvt_pk_bf16_f32 v61, v146, v147
ds_read_b128 v[144:147], v98
s_waitcnt lgkmcnt(12)
v_cvt_pk_bf16_f32 v62, v148, v149
v_cvt_pk_bf16_f32 v63, v150, v151
ds_read_b128 v[148:151], v100
s_waitcnt lgkmcnt(12)
v_cvt_pk_bf16_f32 v64, v152, v153
v_cvt_pk_bf16_f32 v65, v154, v155
ds_read_b128 v[152:155], v106
s_waitcnt lgkmcnt(12)
v_cvt_pk_bf16_f32 v66, v156, v157
v_cvt_pk_bf16_f32 v67, v158, v159
ds_read_b128 v[156:159], v108
s_waitcnt lgkmcnt(12)
v_cvt_pk_bf16_f32 v68, v160, v161
v_cvt_pk_bf16_f32 v69, v162, v163
ds_read_b128 v[160:163], v110
s_waitcnt lgkmcnt(12)
v_cvt_pk_bf16_f32 v74, v164, v165
v_cvt_pk_bf16_f32 v75, v166, v167
ds_read_b128 v[164:167], v112
s_waitcnt lgkmcnt(12)
v_cvt_pk_bf16_f32 v76, v116, v117
v_cvt_pk_bf16_f32 v77, v118, v119
ds_read_b128 v[116:119], v114
s_waitcnt lgkmcnt(12)
v_cvt_pk_bf16_f32 v82, v120, v121
v_cvt_pk_bf16_f32 v83, v122, v123
s_waitcnt lgkmcnt(11)
v_cvt_pk_bf16_f32 v84, v124, v125
v_cvt_pk_bf16_f32 v85, v126, v127
s_waitcnt lgkmcnt(10)
v_cvt_pk_bf16_f32 v90, v128, v129
v_cvt_pk_bf16_f32 v91, v130, v131
s_waitcnt lgkmcnt(9)
v_cvt_pk_bf16_f32 v92, v132, v133
v_cvt_pk_bf16_f32 v93, v134, v135
s_waitcnt lgkmcnt(8)
v_cvt_pk_bf16_f32 v94, v136, v137
v_cvt_pk_bf16_f32 v95, v138, v139
s_waitcnt lgkmcnt(7)
v_cvt_pk_bf16_f32 v96, v140, v141
v_cvt_pk_bf16_f32 v97, v142, v143
s_waitcnt lgkmcnt(6)
v_cvt_pk_bf16_f32 v98, v144, v145
v_cvt_pk_bf16_f32 v99, v146, v147
s_waitcnt lgkmcnt(5)
v_cvt_pk_bf16_f32 v100, v148, v149
v_cvt_pk_bf16_f32 v101, v150, v151
s_waitcnt lgkmcnt(4)
v_cvt_pk_bf16_f32 v106, v152, v153
v_cvt_pk_bf16_f32 v107, v154, v155
s_waitcnt lgkmcnt(3)
v_cvt_pk_bf16_f32 v108, v156, v157
v_cvt_pk_bf16_f32 v109, v158, v159
s_waitcnt lgkmcnt(2)
v_cvt_pk_bf16_f32 v110, v160, v161
v_cvt_pk_bf16_f32 v111, v162, v163
s_waitcnt lgkmcnt(1)
v_cvt_pk_bf16_f32 v112, v164, v165
v_cvt_pk_bf16_f32 v113, v166, v167
s_waitcnt lgkmcnt(0)
v_cvt_pk_bf16_f32 v114, v116, v117
v_cvt_pk_bf16_f32 v115, v118, v119
s_waitcnt vmcnt(15)
v_mfma_f32_16x16x32_bf16 v[156:159], v[16:19], v[176:179], 0
v_mfma_f32_16x16x32_bf16 v[156:159], v[20:23], v[180:183], v[156:159]
v_mfma_f32_16x16x32_bf16 v[160:163], v[24:27], v[180:183], 0
v_mfma_f32_16x16x32_bf16 v[160:163], v[28:31], v[184:187], v[160:163]
v_mfma_f32_16x16x32_bf16 v[160:163], v[32:35], v[188:191], v[160:163]
s_nop 4
v_add_f32 v4, 0x358637bd, v156
v_add_f32 v5, 0x358637bd, v157
v_add_f32 v6, 0x358637bd, v158
v_rcp_f32 v4, v4
v_mfma_f32_16x16x32_bf16 v[164:167], v[36:39], v[188:191], 0
v_rcp_f32 v5, v5
v_rcp_f32 v6, v6
v_mfma_f32_16x16x32_bf16 v[164:167], v[40:43], v[192:195], v[164:167]
v_mfma_f32_16x16x32_bf16 v[116:119], v[44:47], v[176:179], 0
v_add_f32 v7, 0x358637bd, v160
v_add_f32 v8, 0x358637bd, v161
v_add_f32 v9, 0x358637bd, v162
v_add_f32 v10, 0x358637bd, v163
v_mfma_f32_16x16x32_bf16 v[120:123], v[48:51], v[176:179], 0
v_rcp_f32 v7, v7
v_rcp_f32 v8, v8
v_rcp_f32 v9, v9
v_rcp_f32 v10, v10
v_mfma_f32_16x16x32_bf16 v[120:123], v[52:55], v[180:183], v[120:123]
v_add_f32 v11, 0x358637bd, v164
v_add_f32 v12, 0x358637bd, v165
v_add_f32 v13, 0x358637bd, v166
v_rcp_f32 v11, v11
v_mfma_f32_16x16x32_bf16 v[124:127], v[56:59], v[176:179], 0
v_rcp_f32 v12, v12
v_rcp_f32 v13, v13
v_mul_f32 v116, v116, v4
v_mul_f32 v117, v117, v4
v_mfma_f32_16x16x32_bf16 v[124:127], v[60:63], v[180:183], v[124:127]
v_mul_f32 v118, v118, v4
v_mul_f32 v119, v119, v4
v_cvt_pk_bf16_f32 v176, v116, v117
v_cvt_pk_bf16_f32 v177, v118, v119
v_mfma_f32_16x16x32_bf16 v[128:131], v[64:67], v[180:183], 0
v_mul_f32 v120, v120, v5
v_mul_f32 v121, v121, v5
v_mul_f32 v122, v122, v5
v_mul_f32 v123, v123, v5
v_mfma_f32_16x16x32_bf16 v[128:131], v[68:71], v[184:187], v[128:131]
v_cvt_pk_bf16_f32 v178, v120, v121
v_cvt_pk_bf16_f32 v179, v122, v123
v_mfma_f32_16x16x32_bf16 v[132:135], v[72:75], v[180:183], 0
v_mul_f32 v124, v124, v6
v_mul_f32 v125, v125, v6
v_mul_f32 v126, v126, v6
v_mul_f32 v127, v127, v6
v_mfma_f32_16x16x32_bf16 v[132:135], v[76:79], v[184:187], v[132:135]
v_cvt_pk_bf16_f32 v180, v124, v125
v_cvt_pk_bf16_f32 v181, v126, v127
v_mfma_f32_16x16x32_bf16 v[136:139], v[80:83], v[184:187], 0
v_mul_f32 v128, v128, v7
v_mul_f32 v129, v129, v7
v_mul_f32 v130, v130, v7
v_mul_f32 v131, v131, v7
v_mfma_f32_16x16x32_bf16 v[136:139], v[84:87], v[188:191], v[136:139]
v_cvt_pk_bf16_f32 v182, v128, v129
v_cvt_pk_bf16_f32 v183, v130, v131
v_mfma_f32_16x16x32_bf16 v[140:143], v[88:91], v[184:187], 0
v_mul_f32 v132, v132, v8
v_mul_f32 v133, v133, v8
v_mul_f32 v134, v134, v8
v_mul_f32 v135, v135, v8
v_mfma_f32_16x16x32_bf16 v[140:143], v[92:95], v[188:191], v[140:143]
v_cvt_pk_bf16_f32 v184, v132, v133
v_cvt_pk_bf16_f32 v185, v134, v135
v_mfma_f32_16x16x32_bf16 v[144:147], v[96:99], v[188:191], 0
v_mul_f32 v136, v136, v9
v_mul_f32 v137, v137, v9
v_mul_f32 v138, v138, v9
v_mul_f32 v139, v139, v9
v_mfma_f32_16x16x32_bf16 v[144:147], v[100:103], v[192:195], v[144:147]
v_cvt_pk_bf16_f32 v186, v136, v137
v_cvt_pk_bf16_f32 v187, v138, v139
v_mfma_f32_16x16x32_bf16 v[148:151], v[104:107], v[188:191], 0
v_mul_f32 v140, v140, v10
v_mul_f32 v141, v141, v10
v_mul_f32 v142, v142, v10
v_mul_f32 v143, v143, v10
v_mfma_f32_16x16x32_bf16 v[148:151], v[108:111], v[192:195], v[148:151]
v_cvt_pk_bf16_f32 v188, v140, v141
v_cvt_pk_bf16_f32 v189, v142, v143
v_mfma_f32_16x16x32_bf16 v[152:155], v[112:115], v[192:195], 0
v_mul_f32 v144, v144, v11
v_mul_f32 v145, v145, v11
v_mul_f32 v146, v146, v11
v_mul_f32 v147, v147, v11
s_waitcnt vmcnt(10)
v_mfma_f32_16x16x32_bf16 v[156:159], v[16:19], v[196:199], 0
v_cvt_pk_bf16_f32 v190, v144, v145
v_cvt_pk_bf16_f32 v191, v146, v147
v_mfma_f32_16x16x32_bf16 v[156:159], v[20:23], v[200:203], v[156:159]
v_mul_f32 v148, v148, v12
v_mul_f32 v149, v149, v12
v_mul_f32 v150, v150, v12
v_mul_f32 v151, v151, v12
v_mfma_f32_16x16x32_bf16 v[160:163], v[24:27], v[200:203], 0
v_cvt_pk_bf16_f32 v192, v148, v149
v_cvt_pk_bf16_f32 v193, v150, v151
v_mul_f32 v152, v152, v13
v_mul_f32 v153, v153, v13
v_mfma_f32_16x16x32_bf16 v[160:163], v[28:31], v[204:207], v[160:163]
v_mul_f32 v154, v154, v13
v_mul_f32 v155, v155, v13
v_cvt_pk_bf16_f32 v194, v152, v153
v_cvt_pk_bf16_f32 v195, v154, v155
v_mfma_f32_16x16x32_bf16 v[160:163], v[32:35], v[208:211], v[160:163]
v_add_f32 v4, 0x358637bd, v156
v_add_f32 v5, 0x358637bd, v157
v_add_f32 v6, 0x358637bd, v158
v_rcp_f32 v4, v4
v_mfma_f32_16x16x32_bf16 v[164:167], v[36:39], v[208:211], 0
v_rcp_f32 v5, v5
v_rcp_f32 v6, v6
v_mfma_f32_16x16x32_bf16 v[164:167], v[40:43], v[212:215], v[164:167]
v_mfma_f32_16x16x32_bf16 v[116:119], v[44:47], v[196:199], 0
v_add_f32 v7, 0x358637bd, v160
v_add_f32 v8, 0x358637bd, v161
v_add_f32 v9, 0x358637bd, v162
v_add_f32 v10, 0x358637bd, v163
v_mfma_f32_16x16x32_bf16 v[120:123], v[48:51], v[196:199], 0
v_rcp_f32 v7, v7
v_rcp_f32 v8, v8
v_rcp_f32 v9, v9
v_rcp_f32 v10, v10
v_mfma_f32_16x16x32_bf16 v[120:123], v[52:55], v[200:203], v[120:123]
v_add_f32 v11, 0x358637bd, v164
v_add_f32 v12, 0x358637bd, v165
v_add_f32 v13, 0x358637bd, v166
v_rcp_f32 v11, v11
v_mfma_f32_16x16x32_bf16 v[124:127], v[56:59], v[196:199], 0
v_rcp_f32 v12, v12
v_rcp_f32 v13, v13
v_mul_f32 v116, v116, v4
v_mul_f32 v117, v117, v4
v_mfma_f32_16x16x32_bf16 v[124:127], v[60:63], v[200:203], v[124:127]
v_mul_f32 v118, v118, v4
v_mul_f32 v119, v119, v4
v_cvt_pk_bf16_f32 v196, v116, v117
v_cvt_pk_bf16_f32 v197, v118, v119
v_mfma_f32_16x16x32_bf16 v[128:131], v[64:67], v[200:203], 0
v_mul_f32 v120, v120, v5
v_mul_f32 v121, v121, v5
v_mul_f32 v122, v122, v5
v_mul_f32 v123, v123, v5
v_mfma_f32_16x16x32_bf16 v[128:131], v[68:71], v[204:207], v[128:131]
v_cvt_pk_bf16_f32 v198, v120, v121
v_cvt_pk_bf16_f32 v199, v122, v123
v_mfma_f32_16x16x32_bf16 v[132:135], v[72:75], v[200:203], 0
v_mul_f32 v124, v124, v6
v_mul_f32 v125, v125, v6
v_mul_f32 v126, v126, v6
v_mul_f32 v127, v127, v6
v_mfma_f32_16x16x32_bf16 v[132:135], v[76:79], v[204:207], v[132:135]
v_cvt_pk_bf16_f32 v200, v124, v125
v_cvt_pk_bf16_f32 v201, v126, v127
v_mfma_f32_16x16x32_bf16 v[136:139], v[80:83], v[204:207], 0
v_mul_f32 v128, v128, v7
v_mul_f32 v129, v129, v7
v_mul_f32 v130, v130, v7
v_mul_f32 v131, v131, v7
v_mfma_f32_16x16x32_bf16 v[136:139], v[84:87], v[208:211], v[136:139]
v_cvt_pk_bf16_f32 v202, v128, v129
v_cvt_pk_bf16_f32 v203, v130, v131
v_mfma_f32_16x16x32_bf16 v[140:143], v[88:91], v[204:207], 0
v_mul_f32 v132, v132, v8
v_mul_f32 v133, v133, v8
v_mul_f32 v134, v134, v8
v_mul_f32 v135, v135, v8
v_mfma_f32_16x16x32_bf16 v[140:143], v[92:95], v[208:211], v[140:143]
v_cvt_pk_bf16_f32 v204, v132, v133
v_cvt_pk_bf16_f32 v205, v134, v135
v_mfma_f32_16x16x32_bf16 v[144:147], v[96:99], v[208:211], 0
v_mul_f32 v136, v136, v9
v_mul_f32 v137, v137, v9
v_mul_f32 v138, v138, v9
v_mul_f32 v139, v139, v9
v_mfma_f32_16x16x32_bf16 v[144:147], v[100:103], v[212:215], v[144:147]
v_cvt_pk_bf16_f32 v206, v136, v137
v_cvt_pk_bf16_f32 v207, v138, v139
v_mfma_f32_16x16x32_bf16 v[148:151], v[104:107], v[208:211], 0
v_mul_f32 v140, v140, v10
v_mul_f32 v141, v141, v10
v_mul_f32 v142, v142, v10
v_mul_f32 v143, v143, v10
v_mfma_f32_16x16x32_bf16 v[148:151], v[108:111], v[212:215], v[148:151]
v_cvt_pk_bf16_f32 v208, v140, v141
v_cvt_pk_bf16_f32 v209, v142, v143
v_mfma_f32_16x16x32_bf16 v[152:155], v[112:115], v[212:215], 0
v_mul_f32 v144, v144, v11
v_mul_f32 v145, v145, v11
v_mul_f32 v146, v146, v11
v_mul_f32 v147, v147, v11
s_waitcnt vmcnt(5)
v_mfma_f32_16x16x32_bf16 v[156:159], v[16:19], v[216:219], 0
v_cvt_pk_bf16_f32 v210, v144, v145
v_cvt_pk_bf16_f32 v211, v146, v147
v_mfma_f32_16x16x32_bf16 v[156:159], v[20:23], v[220:223], v[156:159]
v_mul_f32 v148, v148, v12
v_mul_f32 v149, v149, v12
v_mul_f32 v150, v150, v12
v_mul_f32 v151, v151, v12
v_mfma_f32_16x16x32_bf16 v[160:163], v[24:27], v[220:223], 0
v_cvt_pk_bf16_f32 v212, v148, v149
v_cvt_pk_bf16_f32 v213, v150, v151
v_mul_f32 v152, v152, v13
v_mul_f32 v153, v153, v13
v_mfma_f32_16x16x32_bf16 v[160:163], v[28:31], v[224:227], v[160:163]
v_mul_f32 v154, v154, v13
v_mul_f32 v155, v155, v13
v_cvt_pk_bf16_f32 v214, v152, v153
v_cvt_pk_bf16_f32 v215, v154, v155
v_mfma_f32_16x16x32_bf16 v[160:163], v[32:35], v[228:231], v[160:163]
v_add_f32 v4, 0x358637bd, v156
v_add_f32 v5, 0x358637bd, v157
v_add_f32 v6, 0x358637bd, v158
v_rcp_f32 v4, v4
v_mfma_f32_16x16x32_bf16 v[164:167], v[36:39], v[228:231], 0
v_rcp_f32 v5, v5
v_rcp_f32 v6, v6
v_mfma_f32_16x16x32_bf16 v[164:167], v[40:43], v[232:235], v[164:167]
v_mfma_f32_16x16x32_bf16 v[116:119], v[44:47], v[216:219], 0
v_add_f32 v7, 0x358637bd, v160
v_add_f32 v8, 0x358637bd, v161
v_add_f32 v9, 0x358637bd, v162
v_add_f32 v10, 0x358637bd, v163
v_mfma_f32_16x16x32_bf16 v[120:123], v[48:51], v[216:219], 0
v_rcp_f32 v7, v7
v_rcp_f32 v8, v8
v_rcp_f32 v9, v9
v_rcp_f32 v10, v10
v_mfma_f32_16x16x32_bf16 v[120:123], v[52:55], v[220:223], v[120:123]
v_add_f32 v11, 0x358637bd, v164
v_add_f32 v12, 0x358637bd, v165
v_add_f32 v13, 0x358637bd, v166
v_rcp_f32 v11, v11
v_mfma_f32_16x16x32_bf16 v[124:127], v[56:59], v[216:219], 0
v_rcp_f32 v12, v12
v_rcp_f32 v13, v13
v_mul_f32 v116, v116, v4
v_mul_f32 v117, v117, v4
v_mfma_f32_16x16x32_bf16 v[124:127], v[60:63], v[220:223], v[124:127]
v_mul_f32 v118, v118, v4
v_mul_f32 v119, v119, v4
v_cvt_pk_bf16_f32 v216, v116, v117
v_cvt_pk_bf16_f32 v217, v118, v119
v_mfma_f32_16x16x32_bf16 v[128:131], v[64:67], v[220:223], 0
v_mul_f32 v120, v120, v5
v_mul_f32 v121, v121, v5
v_mul_f32 v122, v122, v5
v_mul_f32 v123, v123, v5
v_mfma_f32_16x16x32_bf16 v[128:131], v[68:71], v[224:227], v[128:131]
v_cvt_pk_bf16_f32 v218, v120, v121
v_cvt_pk_bf16_f32 v219, v122, v123
v_mfma_f32_16x16x32_bf16 v[132:135], v[72:75], v[220:223], 0
v_mul_f32 v124, v124, v6
v_mul_f32 v125, v125, v6
v_mul_f32 v126, v126, v6
v_mul_f32 v127, v127, v6
v_mfma_f32_16x16x32_bf16 v[132:135], v[76:79], v[224:227], v[132:135]
v_cvt_pk_bf16_f32 v220, v124, v125
v_cvt_pk_bf16_f32 v221, v126, v127
v_mfma_f32_16x16x32_bf16 v[136:139], v[80:83], v[224:227], 0
v_mul_f32 v128, v128, v7
v_mul_f32 v129, v129, v7
v_mul_f32 v130, v130, v7
v_mul_f32 v131, v131, v7
v_mfma_f32_16x16x32_bf16 v[136:139], v[84:87], v[228:231], v[136:139]
v_cvt_pk_bf16_f32 v222, v128, v129
v_cvt_pk_bf16_f32 v223, v130, v131
v_mfma_f32_16x16x32_bf16 v[140:143], v[88:91], v[224:227], 0
v_mul_f32 v132, v132, v8
v_mul_f32 v133, v133, v8
v_mul_f32 v134, v134, v8
v_mul_f32 v135, v135, v8
v_mfma_f32_16x16x32_bf16 v[140:143], v[92:95], v[228:231], v[140:143]
v_cvt_pk_bf16_f32 v224, v132, v133
v_cvt_pk_bf16_f32 v225, v134, v135
v_mfma_f32_16x16x32_bf16 v[144:147], v[96:99], v[228:231], 0
v_mul_f32 v136, v136, v9
v_mul_f32 v137, v137, v9
v_mul_f32 v138, v138, v9
v_mul_f32 v139, v139, v9
v_mfma_f32_16x16x32_bf16 v[144:147], v[100:103], v[232:235], v[144:147]
v_cvt_pk_bf16_f32 v226, v136, v137
v_cvt_pk_bf16_f32 v227, v138, v139
v_mfma_f32_16x16x32_bf16 v[148:151], v[104:107], v[228:231], 0
v_mul_f32 v140, v140, v10
v_mul_f32 v141, v141, v10
v_mul_f32 v142, v142, v10
v_mul_f32 v143, v143, v10
v_mfma_f32_16x16x32_bf16 v[148:151], v[108:111], v[232:235], v[148:151]
v_cvt_pk_bf16_f32 v228, v140, v141
v_cvt_pk_bf16_f32 v229, v142, v143
v_mfma_f32_16x16x32_bf16 v[152:155], v[112:115], v[232:235], 0
v_mul_f32 v144, v144, v11
v_mul_f32 v145, v145, v11
v_mul_f32 v146, v146, v11
v_mul_f32 v147, v147, v11
s_waitcnt vmcnt(0)
v_mfma_f32_16x16x32_bf16 v[156:159], v[16:19], v[236:239], 0
v_cvt_pk_bf16_f32 v230, v144, v145
v_cvt_pk_bf16_f32 v231, v146, v147
v_mfma_f32_16x16x32_bf16 v[156:159], v[20:23], v[240:243], v[156:159]
v_mul_f32 v148, v148, v12
v_mul_f32 v149, v149, v12
v_mul_f32 v150, v150, v12
v_mul_f32 v151, v151, v12
v_mfma_f32_16x16x32_bf16 v[160:163], v[24:27], v[240:243], 0
v_cvt_pk_bf16_f32 v232, v148, v149
v_cvt_pk_bf16_f32 v233, v150, v151
v_mul_f32 v152, v152, v13
v_mul_f32 v153, v153, v13
v_mfma_f32_16x16x32_bf16 v[160:163], v[28:31], v[244:247], v[160:163]
v_mul_f32 v154, v154, v13
v_mul_f32 v155, v155, v13
v_cvt_pk_bf16_f32 v234, v152, v153
v_cvt_pk_bf16_f32 v235, v154, v155
v_mfma_f32_16x16x32_bf16 v[160:163], v[32:35], v[248:251], v[160:163]
v_add_f32 v4, 0x358637bd, v156
v_add_f32 v5, 0x358637bd, v157
v_add_f32 v6, 0x358637bd, v158
v_rcp_f32 v4, v4
v_mfma_f32_16x16x32_bf16 v[164:167], v[36:39], v[248:251], 0
v_rcp_f32 v5, v5
v_rcp_f32 v6, v6
v_mfma_f32_16x16x32_bf16 v[164:167], v[40:43], v[252:255], v[164:167]
v_mfma_f32_16x16x32_bf16 v[116:119], v[44:47], v[236:239], 0
v_add_f32 v7, 0x358637bd, v160
v_add_f32 v8, 0x358637bd, v161
v_add_f32 v9, 0x358637bd, v162
v_add_f32 v10, 0x358637bd, v163
v_mfma_f32_16x16x32_bf16 v[120:123], v[48:51], v[236:239], 0
v_rcp_f32 v7, v7
v_rcp_f32 v8, v8
v_rcp_f32 v9, v9
v_rcp_f32 v10, v10
v_mfma_f32_16x16x32_bf16 v[120:123], v[52:55], v[240:243], v[120:123]
v_add_f32 v11, 0x358637bd, v164
v_add_f32 v12, 0x358637bd, v165
v_add_f32 v13, 0x358637bd, v166
v_rcp_f32 v11, v11
v_mfma_f32_16x16x32_bf16 v[124:127], v[56:59], v[236:239], 0
v_rcp_f32 v12, v12
v_rcp_f32 v13, v13
v_mul_f32 v116, v116, v4
v_mul_f32 v117, v117, v4
v_mfma_f32_16x16x32_bf16 v[124:127], v[60:63], v[240:243], v[124:127]
v_mul_f32 v118, v118, v4
v_mul_f32 v119, v119, v4
v_cvt_pk_bf16_f32 v236, v116, v117
v_cvt_pk_bf16_f32 v237, v118, v119
v_mfma_f32_16x16x32_bf16 v[128:131], v[64:67], v[240:243], 0
v_mul_f32 v120, v120, v5
v_mul_f32 v121, v121, v5
v_mul_f32 v122, v122, v5
v_mul_f32 v123, v123, v5
v_mfma_f32_16x16x32_bf16 v[128:131], v[68:71], v[244:247], v[128:131]
v_cvt_pk_bf16_f32 v238, v120, v121
v_cvt_pk_bf16_f32 v239, v122, v123
v_mfma_f32_16x16x32_bf16 v[132:135], v[72:75], v[240:243], 0
v_mul_f32 v124, v124, v6
v_mul_f32 v125, v125, v6
v_mul_f32 v126, v126, v6
v_mul_f32 v127, v127, v6
v_mfma_f32_16x16x32_bf16 v[132:135], v[76:79], v[244:247], v[132:135]
v_cvt_pk_bf16_f32 v240, v124, v125
v_cvt_pk_bf16_f32 v241, v126, v127
v_mfma_f32_16x16x32_bf16 v[136:139], v[80:83], v[244:247], 0
v_mul_f32 v128, v128, v7
v_mul_f32 v129, v129, v7
v_mul_f32 v130, v130, v7
v_mul_f32 v131, v131, v7
v_mfma_f32_16x16x32_bf16 v[136:139], v[84:87], v[248:251], v[136:139]
v_cvt_pk_bf16_f32 v242, v128, v129
v_cvt_pk_bf16_f32 v243, v130, v131
v_mfma_f32_16x16x32_bf16 v[140:143], v[88:91], v[244:247], 0
v_mul_f32 v132, v132, v8
v_mul_f32 v133, v133, v8
v_mul_f32 v134, v134, v8
v_mul_f32 v135, v135, v8
v_mfma_f32_16x16x32_bf16 v[140:143], v[92:95], v[248:251], v[140:143]
v_cvt_pk_bf16_f32 v244, v132, v133
v_cvt_pk_bf16_f32 v245, v134, v135
v_mfma_f32_16x16x32_bf16 v[144:147], v[96:99], v[248:251], 0
v_mul_f32 v136, v136, v9
v_mul_f32 v137, v137, v9
v_mul_f32 v138, v138, v9
v_mul_f32 v139, v139, v9
v_mfma_f32_16x16x32_bf16 v[144:147], v[100:103], v[252:255], v[144:147]
v_cvt_pk_bf16_f32 v246, v136, v137
v_cvt_pk_bf16_f32 v247, v138, v139
v_mfma_f32_16x16x32_bf16 v[148:151], v[104:107], v[248:251], 0
v_mul_f32 v140, v140, v10
v_mul_f32 v141, v141, v10
v_mul_f32 v142, v142, v10
v_mul_f32 v143, v143, v10
v_mfma_f32_16x16x32_bf16 v[148:151], v[108:111], v[252:255], v[148:151]
v_cvt_pk_bf16_f32 v248, v140, v141
v_cvt_pk_bf16_f32 v249, v142, v143
v_mfma_f32_16x16x32_bf16 v[152:155], v[112:115], v[252:255], 0
v_mul_f32 v144, v144, v11
v_mul_f32 v145, v145, v11
v_mul_f32 v146, v146, v11
v_mul_f32 v147, v147, v11
v_add_u32 v122, s31, v3
s_nop 6
ds_read_b128 v[96:99], v122 offset:0
ds_read_b128 v[100:103], v122 offset:5120
ds_read_b128 v[104:107], v15 offset:0
ds_read_b128 v[108:111], v15 offset:5120
ds_read_b128 v[112:115], v15 offset:10240
v_cvt_pk_bf16_f32 v250, v144, v145
v_cvt_pk_bf16_f32 v251, v146, v147
v_mul_f32 v148, v148, v12
v_mul_f32 v149, v149, v12
v_mul_f32 v150, v150, v12
v_mul_f32 v151, v151, v12
v_cvt_pk_bf16_f32 v252, v148, v149
v_cvt_pk_bf16_f32 v253, v150, v151
v_mul_f32 v152, v152, v13
v_mul_f32 v153, v153, v13
v_mul_f32 v154, v154, v13
v_mul_f32 v155, v155, v13
v_cvt_pk_bf16_f32 v254, v152, v153
v_cvt_pk_bf16_f32 v255, v154, v155
buffer_load_dwordx2 v[124:125], v14, s[56:59], s79 offen offset:0
buffer_load_dwordx2 v[126:127], v14, s[56:59], s79 offen offset:32
buffer_load_dwordx2 v[128:129], v14, s[56:59], s79 offen offset:64
buffer_load_dwordx2 v[130:131], v14, s[56:59], s79 offen offset:96
buffer_load_dwordx2 v[132:133], v14, s[56:59], s79 offen offset:128
s_mul_i32 s30, s78, 15360
v_add_u32 v4, s30, v3
s_sub_u32 s30, s78, 1
s_and_b32 s30, s30, 3
s_mul_i32 s30, s30, 15360
v_add_u32 v5, s30, v3
s_sub_u32 s30, s78, 2
s_and_b32 s30, s30, 3
s_mul_i32 s30, s30, 15360
v_add_u32 v6, s30, v3
s_sub_u32 s30, s78, 3
s_and_b32 s30, s30, 3
s_mul_i32 s30, s30, 15360
v_add_u32 v7, s30, v3
s_waitcnt lgkmcnt(0)
v_mfma_f32_16x16x32_bf16 v[16:19], v[96:99], v[176:179], 0
v_mfma_f32_16x16x32_bf16 v[20:23], v[100:103], v[176:179], 0
ds_read_b128 v[156:159], v122 offset:1024
v_mfma_f32_16x16x32_bf16 v[24:27], v[104:107], v[176:179], 0
ds_read_b128 v[160:163], v122 offset:6144
v_mfma_f32_16x16x32_bf16 v[28:31], v[108:111], v[176:179], 0
ds_read_b128 v[164:167], v15 offset:1024
v_mfma_f32_16x16x32_bf16 v[32:35], v[112:115], v[176:179], 0
ds_read_b128 v[168:171], v15 offset:6144
v_mfma_f32_16x16x32_bf16 v[36:39], v[96:99], v[196:199], 0
ds_read_b128 v[172:175], v15 offset:11264
v_mfma_f32_16x16x32_bf16 v[40:43], v[100:103], v[196:199], 0
v_mfma_f32_16x16x32_bf16 v[44:47], v[104:107], v[196:199], 0
v_mfma_f32_16x16x32_bf16 v[48:51], v[108:111], v[196:199], 0
v_mfma_f32_16x16x32_bf16 v[52:55], v[112:115], v[196:199], 0
v_mfma_f32_16x16x32_bf16 v[56:59], v[96:99], v[216:219], 0
v_mfma_f32_16x16x32_bf16 v[60:63], v[100:103], v[216:219], 0
v_mfma_f32_16x16x32_bf16 v[64:67], v[104:107], v[216:219], 0
v_mfma_f32_16x16x32_bf16 v[68:71], v[108:111], v[216:219], 0
v_mfma_f32_16x16x32_bf16 v[72:75], v[112:115], v[216:219], 0
v_mfma_f32_16x16x32_bf16 v[76:79], v[96:99], v[236:239], 0
v_mfma_f32_16x16x32_bf16 v[80:83], v[100:103], v[236:239], 0
v_mfma_f32_16x16x32_bf16 v[84:87], v[104:107], v[236:239], 0
v_mfma_f32_16x16x32_bf16 v[88:91], v[108:111], v[236:239], 0
v_mfma_f32_16x16x32_bf16 v[92:95], v[112:115], v[236:239], 0
s_waitcnt lgkmcnt(0)
v_mfma_f32_16x16x32_bf16 v[16:19], v[156:159], v[180:183], v[16:19]
v_mfma_f32_16x16x32_bf16 v[20:23], v[160:163], v[180:183], v[20:23]
ds_read_b128 v[96:99], v122 offset:2048
v_mfma_f32_16x16x32_bf16 v[24:27], v[164:167], v[180:183], v[24:27]
ds_read_b128 v[100:103], v122 offset:7168
v_mfma_f32_16x16x32_bf16 v[28:31], v[168:171], v[180:183], v[28:31]
ds_read_b128 v[104:107], v15 offset:2048
v_mfma_f32_16x16x32_bf16 v[32:35], v[172:175], v[180:183], v[32:35]
ds_read_b128 v[108:111], v15 offset:7168
v_mfma_f32_16x16x32_bf16 v[36:39], v[156:159], v[200:203], v[36:39]
ds_read_b128 v[112:115], v15 offset:12288
v_mfma_f32_16x16x32_bf16 v[40:43], v[160:163], v[200:203], v[40:43]
v_mfma_f32_16x16x32_bf16 v[44:47], v[164:167], v[200:203], v[44:47]
v_mfma_f32_16x16x32_bf16 v[48:51], v[168:171], v[200:203], v[48:51]
v_mfma_f32_16x16x32_bf16 v[52:55], v[172:175], v[200:203], v[52:55]
v_mfma_f32_16x16x32_bf16 v[56:59], v[156:159], v[220:223], v[56:59]
v_mfma_f32_16x16x32_bf16 v[60:63], v[160:163], v[220:223], v[60:63]
v_mfma_f32_16x16x32_bf16 v[64:67], v[164:167], v[220:223], v[64:67]
v_mfma_f32_16x16x32_bf16 v[68:71], v[168:171], v[220:223], v[68:71]
v_mfma_f32_16x16x32_bf16 v[72:75], v[172:175], v[220:223], v[72:75]
v_mfma_f32_16x16x32_bf16 v[76:79], v[156:159], v[240:243], v[76:79]
v_mfma_f32_16x16x32_bf16 v[80:83], v[160:163], v[240:243], v[80:83]
v_mfma_f32_16x16x32_bf16 v[84:87], v[164:167], v[240:243], v[84:87]
v_mfma_f32_16x16x32_bf16 v[88:91], v[168:171], v[240:243], v[88:91]
v_mfma_f32_16x16x32_bf16 v[92:95], v[172:175], v[240:243], v[92:95]
s_waitcnt lgkmcnt(0)
v_mfma_f32_16x16x32_bf16 v[16:19], v[96:99], v[184:187], v[16:19]
v_mfma_f32_16x16x32_bf16 v[20:23], v[100:103], v[184:187], v[20:23]
ds_read_b128 v[156:159], v122 offset:3072
v_mfma_f32_16x16x32_bf16 v[24:27], v[104:107], v[184:187], v[24:27]
ds_read_b128 v[160:163], v122 offset:8192
v_mfma_f32_16x16x32_bf16 v[28:31], v[108:111], v[184:187], v[28:31]
ds_read_b128 v[164:167], v15 offset:3072
v_mfma_f32_16x16x32_bf16 v[32:35], v[112:115], v[184:187], v[32:35]
ds_read_b128 v[168:171], v15 offset:8192
v_mfma_f32_16x16x32_bf16 v[36:39], v[96:99], v[204:207], v[36:39]
ds_read_b128 v[172:175], v15 offset:13312
v_mfma_f32_16x16x32_bf16 v[40:43], v[100:103], v[204:207], v[40:43]
v_mfma_f32_16x16x32_bf16 v[44:47], v[104:107], v[204:207], v[44:47]
v_mfma_f32_16x16x32_bf16 v[48:51], v[108:111], v[204:207], v[48:51]
v_mfma_f32_16x16x32_bf16 v[52:55], v[112:115], v[204:207], v[52:55]
v_mfma_f32_16x16x32_bf16 v[56:59], v[96:99], v[224:227], v[56:59]
v_mfma_f32_16x16x32_bf16 v[60:63], v[100:103], v[224:227], v[60:63]
v_mfma_f32_16x16x32_bf16 v[64:67], v[104:107], v[224:227], v[64:67]
v_mfma_f32_16x16x32_bf16 v[68:71], v[108:111], v[224:227], v[68:71]
v_mfma_f32_16x16x32_bf16 v[72:75], v[112:115], v[224:227], v[72:75]
v_mfma_f32_16x16x32_bf16 v[76:79], v[96:99], v[244:247], v[76:79]
v_mfma_f32_16x16x32_bf16 v[80:83], v[100:103], v[244:247], v[80:83]
v_mfma_f32_16x16x32_bf16 v[84:87], v[104:107], v[244:247], v[84:87]
v_mfma_f32_16x16x32_bf16 v[88:91], v[108:111], v[244:247], v[88:91]
v_mfma_f32_16x16x32_bf16 v[92:95], v[112:115], v[244:247], v[92:95]
s_waitcnt lgkmcnt(0)
v_mfma_f32_16x16x32_bf16 v[16:19], v[156:159], v[188:191], v[16:19]
v_mfma_f32_16x16x32_bf16 v[20:23], v[160:163], v[188:191], v[20:23]
ds_read_b128 v[96:99], v122 offset:4096
v_mfma_f32_16x16x32_bf16 v[24:27], v[164:167], v[188:191], v[24:27]
ds_read_b128 v[100:103], v122 offset:9216
v_mfma_f32_16x16x32_bf16 v[28:31], v[168:171], v[188:191], v[28:31]
ds_read_b128 v[104:107], v15 offset:4096
v_mfma_f32_16x16x32_bf16 v[32:35], v[172:175], v[188:191], v[32:35]
ds_read_b128 v[108:111], v15 offset:9216
v_mfma_f32_16x16x32_bf16 v[36:39], v[156:159], v[208:211], v[36:39]
ds_read_b128 v[112:115], v15 offset:14336
v_mfma_f32_16x16x32_bf16 v[40:43], v[160:163], v[208:211], v[40:43]
v_mfma_f32_16x16x32_bf16 v[44:47], v[164:167], v[208:211], v[44:47]
v_mfma_f32_16x16x32_bf16 v[48:51], v[168:171], v[208:211], v[48:51]
v_mfma_f32_16x16x32_bf16 v[52:55], v[172:175], v[208:211], v[52:55]
v_mfma_f32_16x16x32_bf16 v[56:59], v[156:159], v[228:231], v[56:59]
v_mfma_f32_16x16x32_bf16 v[60:63], v[160:163], v[228:231], v[60:63]
v_mfma_f32_16x16x32_bf16 v[64:67], v[164:167], v[228:231], v[64:67]
v_mfma_f32_16x16x32_bf16 v[68:71], v[168:171], v[228:231], v[68:71]
v_mfma_f32_16x16x32_bf16 v[72:75], v[172:175], v[228:231], v[72:75]
v_mfma_f32_16x16x32_bf16 v[76:79], v[156:159], v[248:251], v[76:79]
v_mfma_f32_16x16x32_bf16 v[80:83], v[160:163], v[248:251], v[80:83]
v_mfma_f32_16x16x32_bf16 v[84:87], v[164:167], v[248:251], v[84:87]
v_mfma_f32_16x16x32_bf16 v[88:91], v[168:171], v[248:251], v[88:91]
v_mfma_f32_16x16x32_bf16 v[92:95], v[172:175], v[248:251], v[92:95]
s_waitcnt lgkmcnt(0)
v_mfma_f32_16x16x32_bf16 v[36:39], v[96:99], v[212:215], v[36:39]
v_mfma_f32_16x16x32_bf16 v[40:43], v[100:103], v[212:215], v[40:43]
v_mfma_f32_16x16x32_bf16 v[44:47], v[104:107], v[212:215], v[44:47]
v_mfma_f32_16x16x32_bf16 v[48:51], v[108:111], v[212:215], v[48:51]
v_mfma_f32_16x16x32_bf16 v[52:55], v[112:115], v[212:215], v[52:55]
v_mfma_f32_16x16x32_bf16 v[56:59], v[96:99], v[232:235], v[56:59]
s_nop 2
ds_write_b128 v4, v[36:39] offset:0
v_mfma_f32_16x16x32_bf16 v[60:63], v[100:103], v[232:235], v[60:63]
ds_write_b128 v4, v[40:43] offset:1024
v_mfma_f32_16x16x32_bf16 v[64:67], v[104:107], v[232:235], v[64:67]
ds_write_b128 v4, v[44:47] offset:2048
v_mfma_f32_16x16x32_bf16 v[68:71], v[108:111], v[232:235], v[68:71]
ds_write_b128 v4, v[48:51] offset:3072
v_mfma_f32_16x16x32_bf16 v[72:75], v[112:115], v[232:235], v[72:75]
ds_write_b128 v4, v[52:55] offset:4096
v_mfma_f32_16x16x32_bf16 v[76:79], v[96:99], v[252:255], v[76:79]
ds_write_b128 v4, v[56:59] offset:5120
v_mfma_f32_16x16x32_bf16 v[80:83], v[100:103], v[252:255], v[80:83]
ds_write_b128 v4, v[60:63] offset:6144
v_mfma_f32_16x16x32_bf16 v[84:87], v[104:107], v[252:255], v[84:87]
ds_write_b128 v4, v[64:67] offset:7168
v_mfma_f32_16x16x32_bf16 v[88:91], v[108:111], v[252:255], v[88:91]
ds_write_b128 v4, v[68:71] offset:8192
v_mfma_f32_16x16x32_bf16 v[92:95], v[112:115], v[252:255], v[92:95]
ds_write_b128 v4, v[72:75] offset:9216
v_mfma_f32_16x16x32_bf16 v[16:19], v[96:99], v[192:195], v[16:19]
ds_write_b128 v4, v[76:79] offset:10240
v_mfma_f32_16x16x32_bf16 v[20:23], v[100:103], v[192:195], v[20:23]
ds_write_b128 v4, v[80:83] offset:11264
v_mfma_f32_16x16x32_bf16 v[24:27], v[104:107], v[192:195], v[24:27]
ds_write_b128 v4, v[84:87] offset:12288
v_mfma_f32_16x16x32_bf16 v[28:31], v[108:111], v[192:195], v[28:31]
ds_write_b128 v4, v[88:91] offset:13312
v_mfma_f32_16x16x32_bf16 v[32:35], v[112:115], v[192:195], v[32:35]
ds_write_b128 v4, v[92:95] offset:14336
s_waitcnt lgkmcnt(0)
s_barrier
ds_read_b128 v[36:39], v5 offset:0
ds_read_b128 v[40:43], v6 offset:5120
ds_read_b128 v[44:47], v7 offset:10240
ds_read_b128 v[48:51], v5 offset:1024
ds_read_b128 v[52:55], v6 offset:6144
ds_read_b128 v[56:59], v7 offset:11264
ds_read_b128 v[60:63], v5 offset:2048
ds_read_b128 v[64:67], v6 offset:7168
ds_read_b128 v[68:71], v7 offset:12288
ds_read_b128 v[72:75], v5 offset:3072
ds_read_b128 v[76:79], v6 offset:8192
ds_read_b128 v[80:83], v7 offset:13312
ds_read_b128 v[84:87], v5 offset:4096
ds_read_b128 v[88:91], v6 offset:9216
ds_read_b128 v[92:95], v7 offset:14336
s_waitcnt vmcnt(0)
s_waitcnt lgkmcnt(12)
v_pk_add_f32 v[16:17], v[16:17], v[36:37]
v_pk_add_f32 v[40:41], v[40:41], v[44:45]
v_lshlrev_b32 v12, 16, v124
v_and_b32 v13, 0xffff0000, v124
v_pk_add_f32 v[16:17], v[16:17], v[40:41]
v_pk_add_f32 v[16:17], v[16:17], v[12:13]
v_cvt_pk_bf16_f32 v112, v16, v17
v_pk_add_f32 v[18:19], v[18:19], v[38:39]
v_pk_add_f32 v[42:43], v[42:43], v[46:47]
v_lshlrev_b32 v12, 16, v125
v_and_b32 v13, 0xffff0000, v125
v_pk_add_f32 v[18:19], v[18:19], v[42:43]
v_pk_add_f32 v[18:19], v[18:19], v[12:13]
v_cvt_pk_bf16_f32 v113, v18, v19
s_waitcnt lgkmcnt(9)
v_pk_add_f32 v[20:21], v[20:21], v[48:49]
v_pk_add_f32 v[52:53], v[52:53], v[56:57]
v_lshlrev_b32 v12, 16, v126
v_and_b32 v13, 0xffff0000, v126
v_pk_add_f32 v[20:21], v[20:21], v[52:53]
v_pk_add_f32 v[20:21], v[20:21], v[12:13]
v_cvt_pk_bf16_f32 v114, v20, v21
v_pk_add_f32 v[22:23], v[22:23], v[50:51]
v_pk_add_f32 v[54:55], v[54:55], v[58:59]
v_lshlrev_b32 v12, 16, v127
v_and_b32 v13, 0xffff0000, v127
v_pk_add_f32 v[22:23], v[22:23], v[54:55]
v_pk_add_f32 v[22:23], v[22:23], v[12:13]
v_cvt_pk_bf16_f32 v115, v22, v23
v_permlane32_swap_b32 v112, v114
s_nop 0
v_permlane32_swap_b32 v113, v115
buffer_store_dwordx4 v[112:115], v3, s[40:43], s66 offen offset:0 sc1
s_waitcnt lgkmcnt(6)
v_pk_add_f32 v[24:25], v[24:25], v[60:61]
v_pk_add_f32 v[64:65], v[64:65], v[68:69]
v_lshlrev_b32 v12, 16, v128
v_and_b32 v13, 0xffff0000, v128
v_pk_add_f32 v[24:25], v[24:25], v[64:65]
v_pk_add_f32 v[24:25], v[24:25], v[12:13]
v_cvt_pk_bf16_f32 v116, v24, v25
v_pk_add_f32 v[26:27], v[26:27], v[62:63]
v_pk_add_f32 v[66:67], v[66:67], v[70:71]
v_lshlrev_b32 v12, 16, v129
v_and_b32 v13, 0xffff0000, v129
v_pk_add_f32 v[26:27], v[26:27], v[66:67]
v_pk_add_f32 v[26:27], v[26:27], v[12:13]
v_cvt_pk_bf16_f32 v117, v26, v27
s_waitcnt lgkmcnt(3)
v_pk_add_f32 v[28:29], v[28:29], v[72:73]
v_pk_add_f32 v[76:77], v[76:77], v[80:81]
v_lshlrev_b32 v12, 16, v130
v_and_b32 v13, 0xffff0000, v130
v_pk_add_f32 v[28:29], v[28:29], v[76:77]
v_pk_add_f32 v[28:29], v[28:29], v[12:13]
v_cvt_pk_bf16_f32 v118, v28, v29
v_pk_add_f32 v[30:31], v[30:31], v[74:75]
v_pk_add_f32 v[78:79], v[78:79], v[82:83]
v_lshlrev_b32 v12, 16, v131
v_and_b32 v13, 0xffff0000, v131
v_pk_add_f32 v[30:31], v[30:31], v[78:79]
v_pk_add_f32 v[30:31], v[30:31], v[12:13]
v_cvt_pk_bf16_f32 v119, v30, v31
v_permlane32_swap_b32 v116, v118
s_nop 0
v_permlane32_swap_b32 v117, v119
buffer_store_dwordx4 v[116:119], v3, s[40:43], s66 offen offset:1024 sc1
s_waitcnt lgkmcnt(0)
v_pk_add_f32 v[32:33], v[32:33], v[84:85]
v_pk_add_f32 v[88:89], v[88:89], v[92:93]
v_lshlrev_b32 v12, 16, v132
v_and_b32 v13, 0xffff0000, v132
v_pk_add_f32 v[32:33], v[32:33], v[88:89]
v_pk_add_f32 v[32:33], v[32:33], v[12:13]
v_cvt_pk_bf16_f32 v120, v32, v33
v_pk_add_f32 v[34:35], v[34:35], v[86:87]
v_pk_add_f32 v[90:91], v[90:91], v[94:95]
v_lshlrev_b32 v12, 16, v133
v_and_b32 v13, 0xffff0000, v133
v_pk_add_f32 v[34:35], v[34:35], v[90:91]
v_pk_add_f32 v[34:35], v[34:35], v[12:13]
v_cvt_pk_bf16_f32 v121, v34, v35
v_permlane32_swap_b32 v120, v122
s_nop 0
v_permlane32_swap_b32 v121, v123
s_mov_b32 exec_hi, 0
buffer_store_dwordx4 v[120:123], v3, s[40:43], s66 offen offset:2048 sc1
s_mov_b32 exec_hi, -1
v_permlane32_swap_b32 v112, v114
v_permlane32_swap_b32 v113, v115
v_permlane32_swap_b32 v116, v118
v_permlane32_swap_b32 v117, v119
v_permlane32_swap_b32 v120, v122
v_permlane32_swap_b32 v121, v123
v_mov_b32 v8, 0
v_mov_b32 v9, 0
v_mov_b32 v10, 0x3f803f80
v_dot2_f32_bf16 v8, v112, v10, v8
v_dot2_f32_bf16 v9, v112, v112, v9
v_dot2_f32_bf16 v8, v113, v10, v8
v_dot2_f32_bf16 v9, v113, v113, v9
v_dot2_f32_bf16 v8, v114, v10, v8
v_dot2_f32_bf16 v9, v114, v114, v9
v_dot2_f32_bf16 v8, v115, v10, v8
v_dot2_f32_bf16 v9, v115, v115, v9
v_dot2_f32_bf16 v8, v116, v10, v8
v_dot2_f32_bf16 v9, v116, v116, v9
v_dot2_f32_bf16 v8, v117, v10, v8
v_dot2_f32_bf16 v9, v117, v117, v9
v_dot2_f32_bf16 v8, v118, v10, v8
v_dot2_f32_bf16 v9, v118, v118, v9
v_dot2_f32_bf16 v8, v119, v10, v8
v_dot2_f32_bf16 v9, v119, v119, v9
v_dot2_f32_bf16 v8, v120, v10, v8
v_dot2_f32_bf16 v9, v120, v120, v9
v_dot2_f32_bf16 v8, v121, v10, v8
v_dot2_f32_bf16 v9, v121, v121, v9
s_nop 1
v_mov_b32 v10, v8
s_nop 1
v_permlane32_swap_b32 v8, v10
v_add_f32 v8, v8, v10
v_mov_b32 v10, v8
s_nop 1
v_permlane16_swap_b32 v8, v10
v_add_f32 v8, v8, v10
v_mov_b32 v11, v9
s_nop 1
v_permlane32_swap_b32 v9, v11
v_add_f32 v9, v9, v11
v_mov_b32 v11, v9
s_nop 1
v_permlane16_swap_b32 v9, v11
v_add_f32 v9, v9, v11
v_cmp_gt_u32 vcc, 16, v0
v_mov_b32 v12, 1073741824
s_lshr_b32 s31, s28, 1
s_lshl2_add_u32 s30, s29, s31
s_lshl_b32 s30, s30, 8
s_and_b32 s31, s28, 1
s_lshl3_add_u32 s30, s31, s30
s_add_u32 s30, s30, 3407872
v_cndmask_b32 v12, v12, v3, vcc
buffer_store_dwordx2 v[8:9], v12, s[40:43], s30 offen sc1
s_lshr_b32 s30, s78, 1
s_and_b32 s31, s78, 1
s_lshl_b32 s32, s30, 13
s_add_u32 s32, s32, 81920
v_add_u32 v4, s32, v3
s_mul_i32 s32, s31, 6144
s_add_u32 s32, s32, 98304
v_add_u32 v5, s32, v3
s_lshl1_add_u32 s33, s60, s30
s_mul_i32 s33, s33, 192
s_mul_i32 s32, s61, 3
s_add_u32 s33, s33, s32
s_lshl_b32 s33, s33, 10
s_add_u32 s33, s33, 8388608
s_mul_i32 s32, s31, 1536
s_add_u32 s50, s33, s32
s_mul_i32 s32, s31, 192
v_lshl_add_u32 v6, v1, 4, s32
v_lshrrev_b32 v7, 5, v0
v_mul_u32_u24 v7, 48640, v7
v_add_u32 v7, v7, v3
s_lshl_b32 s32, s30, 9
v_lshl_add_u32 v15, v2, 3, s32
s_mul_i32 s66, s28, 245760
s_mul_i32 s32, s78, 12288
s_add_u32 s66, s66, s32
s_add_u32 s66, s66, 22020096
s_add_u32 s32, s32, 8388608
s_mov_b32 s37, 0
s_mov_b32 s38, 81920
s_mov_b32 s49, 40960
s_add_u32 s67, s66, 49152
s_add_u32 s71, s71, s32
s_add_u32 s68, s66, 98304
s_add_u32 s72, s72, s32
s_add_u32 s69, s66, 147456
s_add_u32 s73, s73, s32
s_add_u32 s70, s66, 196608
s_add_u32 s74, s74, s32
v_mov_b32 v128, 0
v_mov_b32 v129, 0
v_mov_b32 v130, 0
v_mov_b32 v131, 0
v_mov_b32 v132, 0
v_mov_b32 v133, 0
v_mov_b32 v134, 0
v_mov_b32 v135, 0
v_mov_b32 v136, 0
v_mov_b32 v137, 0
v_mov_b32 v138, 0
v_mov_b32 v139, 0
v_mov_b32 v140, 0
v_mov_b32 v141, 0
v_mov_b32 v142, 0
v_mov_b32 v143, 0
v_mov_b32 v144, 0
v_mov_b32 v145, 0
v_mov_b32 v146, 0
v_mov_b32 v147, 0
v_mov_b32 v148, 0
v_mov_b32 v149, 0
v_mov_b32 v150, 0
v_mov_b32 v151, 0
v_mov_b32 v152, 0
v_mov_b32 v153, 0
v_mov_b32 v154, 0
v_mov_b32 v155, 0
v_mov_b32 v156, 0
v_mov_b32 v157, 0
v_mov_b32 v158, 0
v_mov_b32 v159, 0
v_mov_b32 v160, 0
v_mov_b32 v161, 0
v_mov_b32 v162, 0
v_mov_b32 v163, 0
v_mov_b32 v164, 0
v_mov_b32 v165, 0
v_mov_b32 v166, 0
v_mov_b32 v167, 0
v_mov_b32 v168, 0
v_mov_b32 v169, 0
v_mov_b32 v170, 0
v_mov_b32 v171, 0
v_mov_b32 v172, 0
v_mov_b32 v173, 0
v_mov_b32 v174, 0
v_mov_b32 v175, 0
v_mov_b32 v176, 0
v_mov_b32 v177, 0
v_mov_b32 v178, 0
v_mov_b32 v179, 0
v_mov_b32 v180, 0
v_mov_b32 v181, 0
v_mov_b32 v182, 0
v_mov_b32 v183, 0
v_mov_b32 v184, 0
v_mov_b32 v185, 0
v_mov_b32 v186, 0
v_mov_b32 v187, 0
v_mov_b32 v188, 0
v_mov_b32 v189, 0
v_mov_b32 v190, 0
v_mov_b32 v191, 0
v_mov_b32 v192, 0
v_mov_b32 v193, 0
v_mov_b32 v194, 0
v_mov_b32 v195, 0
v_mov_b32 v196, 0
v_mov_b32 v197, 0
v_mov_b32 v198, 0
v_mov_b32 v199, 0
v_mov_b32 v200, 0
v_mov_b32 v201, 0
v_mov_b32 v202, 0
v_mov_b32 v203, 0
v_mov_b32 v204, 0
v_mov_b32 v205, 0
v_mov_b32 v206, 0
v_mov_b32 v207, 0
v_mov_b32 v208, 0
v_mov_b32 v209, 0
v_mov_b32 v210, 0
v_mov_b32 v211, 0
v_mov_b32 v212, 0
v_mov_b32 v213, 0
v_mov_b32 v214, 0
v_mov_b32 v215, 0
v_mov_b32 v216, 0
v_mov_b32 v217, 0
v_mov_b32 v218, 0
v_mov_b32 v219, 0
v_mov_b32 v220, 0
v_mov_b32 v221, 0
v_mov_b32 v222, 0
v_mov_b32 v223, 0
s_waitcnt vmcnt(0)
s_barrier
s_barrier
s_barrier
ds_read_b128 v[32:35], v4 offset:0
ds_read_b128 v[36:39], v4 offset:2048
ds_read_b128 v[40:43], v4 offset:4096
ds_read_b128 v[44:47], v4 offset:6144
ds_read_b128 v[48:51], v5 offset:0
ds_read_b128 v[52:55], v5 offset:2048
ds_read_b128 v[56:59], v5 offset:4096
ds_read_b128 v[60:63], v5 offset:12288
ds_read_b128 v[64:67], v5 offset:14336
ds_read_b128 v[68:71], v5 offset:16384
.p2align 6
L3m:
s_waitcnt lgkmcnt(0)
v_mfma_f32_16x16x32_bf16 v[128:131], v[48:51], v[32:35], v[128:131]
ds_read_b128 v[72:75], v4 offset:1024
v_mfma_f32_16x16x32_bf16 v[152:155], v[48:51], v[36:39], v[152:155]
ds_read_b128 v[76:79], v4 offset:3072
v_mfma_f32_16x16x32_bf16 v[176:179], v[48:51], v[40:43], v[176:179]
ds_read_b128 v[80:83], v4 offset:5120
v_mfma_f32_16x16x32_bf16 v[200:203], v[48:51], v[44:47], v[200:203]
ds_read_b128 v[84:87], v4 offset:7168
v_mfma_f32_16x16x32_bf16 v[132:135], v[52:55], v[32:35], v[132:135]
ds_read_b128 v[88:91], v5 offset:1024
v_mfma_f32_16x16x32_bf16 v[156:159], v[52:55], v[36:39], v[156:159]
ds_read_b128 v[92:95], v5 offset:3072
v_mfma_f32_16x16x32_bf16 v[180:183], v[52:55], v[40:43], v[180:183]
ds_read_b128 v[96:99], v5 offset:5120
v_mfma_f32_16x16x32_bf16 v[204:207], v[52:55], v[44:47], v[204:207]
ds_read_b128 v[100:103], v5 offset:13312
v_mfma_f32_16x16x32_bf16 v[136:139], v[56:59], v[32:35], v[136:139]
ds_read_b128 v[104:107], v5 offset:15360
v_mfma_f32_16x16x32_bf16 v[160:163], v[56:59], v[36:39], v[160:163]
ds_read_b128 v[108:111], v5 offset:17408
v_mfma_f32_16x16x32_bf16 v[184:187], v[56:59], v[40:43], v[184:187]
v_mfma_f32_16x16x32_bf16 v[208:211], v[56:59], v[44:47], v[208:211]
v_mfma_f32_16x16x32_bf16 v[140:143], v[60:63], v[32:35], v[140:143]
v_mfma_f32_16x16x32_bf16 v[164:167], v[60:63], v[36:39], v[164:167]
v_mfma_f32_16x16x32_bf16 v[188:191], v[60:63], v[40:43], v[188:191]
v_mfma_f32_16x16x32_bf16 v[212:215], v[60:63], v[44:47], v[212:215]
v_mfma_f32_16x16x32_bf16 v[144:147], v[64:67], v[32:35], v[144:147]
v_mfma_f32_16x16x32_bf16 v[168:171], v[64:67], v[36:39], v[168:171]
v_mfma_f32_16x16x32_bf16 v[192:195], v[64:67], v[40:43], v[192:195]
v_mfma_f32_16x16x32_bf16 v[216:219], v[64:67], v[44:47], v[216:219]
v_mfma_f32_16x16x32_bf16 v[148:151], v[68:71], v[32:35], v[148:151]
v_mfma_f32_16x16x32_bf16 v[172:175], v[68:71], v[36:39], v[172:175]
v_mfma_f32_16x16x32_bf16 v[196:199], v[68:71], v[40:43], v[196:199]
v_mfma_f32_16x16x32_bf16 v[220:223], v[68:71], v[44:47], v[220:223]
s_add_u32 s37, s37, 1
s_cmp_eq_u32 s38, 122880
s_cselect_b32 s48, -81920, s49
s_add_u32 s38, s38, s48
v_add_u32 v4, s48, v4
v_add_u32 v5, s48, v5
s_waitcnt lgkmcnt(0)
s_barrier
v_mfma_f32_16x16x32_bf16 v[128:131], v[88:91], v[72:75], v[128:131]
ds_read_b128 v[32:35], v4 offset:0
v_mfma_f32_16x16x32_bf16 v[152:155], v[88:91], v[76:79], v[152:155]
ds_read_b128 v[36:39], v4 offset:2048
v_mfma_f32_16x16x32_bf16 v[176:179], v[88:91], v[80:83], v[176:179]
ds_read_b128 v[40:43], v4 offset:4096
v_mfma_f32_16x16x32_bf16 v[200:203], v[88:91], v[84:87], v[200:203]
ds_read_b128 v[44:47], v4 offset:6144
v_mfma_f32_16x16x32_bf16 v[132:135], v[92:95], v[72:75], v[132:135]
ds_read_b128 v[48:51], v5 offset:0
v_mfma_f32_16x16x32_bf16 v[156:159], v[92:95], v[76:79], v[156:159]
ds_read_b128 v[52:55], v5 offset:2048
v_mfma_f32_16x16x32_bf16 v[180:183], v[92:95], v[80:83], v[180:183]
ds_read_b128 v[56:59], v5 offset:4096
v_mfma_f32_16x16x32_bf16 v[204:207], v[92:95], v[84:87], v[204:207]
ds_read_b128 v[60:63], v5 offset:12288
v_mfma_f32_16x16x32_bf16 v[136:139], v[96:99], v[72:75], v[136:139]
ds_read_b128 v[64:67], v5 offset:14336
v_mfma_f32_16x16x32_bf16 v[160:163], v[96:99], v[76:79], v[160:163]
ds_read_b128 v[68:71], v5 offset:16384
v_mfma_f32_16x16x32_bf16 v[184:187], v[96:99], v[80:83], v[184:187]
v_mfma_f32_16x16x32_bf16 v[208:211], v[96:99], v[84:87], v[208:211]
v_mfma_f32_16x16x32_bf16 v[140:143], v[100:103], v[72:75], v[140:143]
v_mfma_f32_16x16x32_bf16 v[164:167], v[100:103], v[76:79], v[164:167]
v_mfma_f32_16x16x32_bf16 v[188:191], v[100:103], v[80:83], v[188:191]
v_mfma_f32_16x16x32_bf16 v[212:215], v[100:103], v[84:87], v[212:215]
v_mfma_f32_16x16x32_bf16 v[144:147], v[104:107], v[72:75], v[144:147]
v_mfma_f32_16x16x32_bf16 v[168:171], v[104:107], v[76:79], v[168:171]
v_mfma_f32_16x16x32_bf16 v[192:195], v[104:107], v[80:83], v[192:195]
v_mfma_f32_16x16x32_bf16 v[216:219], v[104:107], v[84:87], v[216:219]
v_mfma_f32_16x16x32_bf16 v[148:151], v[108:111], v[72:75], v[148:151]
v_mfma_f32_16x16x32_bf16 v[172:175], v[108:111], v[76:79], v[172:175]
v_mfma_f32_16x16x32_bf16 v[196:199], v[108:111], v[80:83], v[196:199]
v_mfma_f32_16x16x32_bf16 v[220:223], v[108:111], v[84:87], v[220:223]
s_cmp_lt_u32 s37, 10
s_cbranch_scc1 L3m
Ldt40:
Lpd4_0:
s_cbranch_execz Lpd4_1
ds_read_b128 v[224:227], v6 offset:0
ds_read_b128 v[228:231], v6 offset:64
ds_read_b128 v[232:235], v6 offset:128
ds_read_b128 v[236:239], v6 offset:384
ds_read_b128 v[240:243], v6 offset:448
ds_read_b128 v[244:247], v6 offset:512
ds_read_b64 v[248:249], v15 offset:1024
ds_read_b64 v[250:251], v15 offset:1152
ds_read_b64 v[252:253], v15 offset:1280
ds_read_b64 v[254:255], v15 offset:1408
Lpd4_1:
s_cbranch_execz Lpd4_2
s_waitcnt lgkmcnt(0)
v_pk_fma_f32 v[128:129], v[248:249], v[224:225], v[128:129] op_sel_hi:[0,1,1]
v_pk_fma_f32 v[140:141], v[248:249], v[236:237], v[140:141] op_sel_hi:[0,1,1]
v_max_f32 v128, 0, v128
v_max_f32 v129, 0, v129
v_pk_mul_f32 v[140:141], v[140:141], v[248:249] op_sel:[0,1]
v_pk_mul_f32 v[128:129], v[128:129], v[140:141]
v_cvt_pk_bf16_f32 v128, v128, v129
v_pk_fma_f32 v[130:131], v[248:249], v[226:227], v[130:131] op_sel_hi:[0,1,1]
v_pk_fma_f32 v[142:143], v[248:249], v[238:239], v[142:143] op_sel_hi:[0,1,1]
Lpd4_2:
s_cbranch_execz Lpd4_3
v_max_f32 v130, 0, v130
v_max_f32 v131, 0, v131
v_pk_mul_f32 v[142:143], v[142:143], v[248:249] op_sel:[0,1]
v_pk_mul_f32 v[130:131], v[130:131], v[142:143]
v_cvt_pk_bf16_f32 v129, v130, v131
v_pk_fma_f32 v[132:133], v[248:249], v[228:229], v[132:133] op_sel_hi:[0,1,1]
v_pk_fma_f32 v[144:145], v[248:249], v[240:241], v[144:145] op_sel_hi:[0,1,1]
v_max_f32 v132, 0, v132
v_max_f32 v133, 0, v133
v_pk_mul_f32 v[144:145], v[144:145], v[248:249] op_sel:[0,1]
Lpd4_3:
s_cbranch_execz Lpd4_4
v_pk_mul_f32 v[132:133], v[132:133], v[144:145]
v_cvt_pk_bf16_f32 v130, v132, v133
v_pk_fma_f32 v[134:135], v[248:249], v[230:231], v[134:135] op_sel_hi:[0,1,1]
v_pk_fma_f32 v[146:147], v[248:249], v[242:243], v[146:147] op_sel_hi:[0,1,1]
v_max_f32 v134, 0, v134
v_max_f32 v135, 0, v135
v_pk_mul_f32 v[146:147], v[146:147], v[248:249] op_sel:[0,1]
v_pk_mul_f32 v[134:135], v[134:135], v[146:147]
v_cvt_pk_bf16_f32 v131, v134, v135
v_permlane32_swap_b32 v128, v130
Lpd4_4:
s_cbranch_execz Lpd4_5
v_permlane32_swap_b32 v129, v131
s_add_u32 s51, s50, 0
buffer_store_dwordx4 v[128:131], v3, s[40:43], s51 offen sc1
v_pk_fma_f32 v[136:137], v[248:249], v[232:233], v[136:137] op_sel_hi:[0,1,1]
v_pk_fma_f32 v[148:149], v[248:249], v[244:245], v[148:149] op_sel_hi:[0,1,1]
v_max_f32 v136, 0, v136
v_max_f32 v137, 0, v137
v_pk_mul_f32 v[148:149], v[148:149], v[248:249] op_sel:[0,1]
v_pk_mul_f32 v[136:137], v[136:137], v[148:149]
v_cvt_pk_bf16_f32 v132, v136, v137
Lpd4_5:
s_cbranch_execz Lpd4_6
v_pk_fma_f32 v[138:139], v[248:249], v[234:235], v[138:139] op_sel_hi:[0,1,1]
v_pk_fma_f32 v[150:151], v[248:249], v[246:247], v[150:151] op_sel_hi:[0,1,1]
v_max_f32 v138, 0, v138
v_max_f32 v139, 0, v139
v_pk_mul_f32 v[150:151], v[150:151], v[248:249] op_sel:[0,1]
v_pk_mul_f32 v[138:139], v[138:139], v[150:151]
v_cvt_pk_bf16_f32 v133, v138, v139
v_pk_fma_f32 v[152:153], v[250:251], v[224:225], v[152:153] op_sel_hi:[0,1,1]
v_pk_fma_f32 v[164:165], v[250:251], v[236:237], v[164:165] op_sel_hi:[0,1,1]
v_max_f32 v152, 0, v152
Lpd4_6:
s_cbranch_execz Lpd4_7
v_max_f32 v153, 0, v153
v_pk_mul_f32 v[164:165], v[164:165], v[250:251] op_sel:[0,1]
v_pk_mul_f32 v[152:153], v[152:153], v[164:165]
v_cvt_pk_bf16_f32 v152, v152, v153
v_pk_fma_f32 v[154:155], v[250:251], v[226:227], v[154:155] op_sel_hi:[0,1,1]
v_pk_fma_f32 v[166:167], v[250:251], v[238:239], v[166:167] op_sel_hi:[0,1,1]
v_max_f32 v154, 0, v154
v_max_f32 v155, 0, v155
v_pk_mul_f32 v[166:167], v[166:167], v[250:251] op_sel:[0,1]
v_pk_mul_f32 v[154:155], v[154:155], v[166:167]
Lpd4_7:
s_cbranch_execz Lpd4_8
v_cvt_pk_bf16_f32 v153, v154, v155
v_pk_fma_f32 v[156:157], v[250:251], v[228:229], v[156:157] op_sel_hi:[0,1,1]
v_pk_fma_f32 v[168:169], v[250:251], v[240:241], v[168:169] op_sel_hi:[0,1,1]
v_max_f32 v156, 0, v156
v_max_f32 v157, 0, v157
v_pk_mul_f32 v[168:169], v[168:169], v[250:251] op_sel:[0,1]
v_pk_mul_f32 v[156:157], v[156:157], v[168:169]
v_cvt_pk_bf16_f32 v154, v156, v157
v_pk_fma_f32 v[158:159], v[250:251], v[230:231], v[158:159] op_sel_hi:[0,1,1]
v_pk_fma_f32 v[170:171], v[250:251], v[242:243], v[170:171] op_sel_hi:[0,1,1]
Lpd4_8:
s_cbranch_execz Lpd4_9
v_max_f32 v158, 0, v158
v_max_f32 v159, 0, v159
v_pk_mul_f32 v[170:171], v[170:171], v[250:251] op_sel:[0,1]
v_pk_mul_f32 v[158:159], v[158:159], v[170:171]
v_cvt_pk_bf16_f32 v155, v158, v159
v_permlane32_swap_b32 v152, v154
s_nop 0
v_permlane32_swap_b32 v153, v155
s_add_u32 s51, s50, 49152
buffer_store_dwordx4 v[152:155], v3, s[40:43], s51 offen sc1
v_pk_fma_f32 v[160:161], v[250:251], v[232:233], v[160:161] op_sel_hi:[0,1,1]
Lpd4_9:
s_cbranch_execz Lpd4_10
v_pk_fma_f32 v[172:173], v[250:251], v[244:245], v[172:173] op_sel_hi:[0,1,1]
v_max_f32 v160, 0, v160
v_max_f32 v161, 0, v161
v_pk_mul_f32 v[172:173], v[172:173], v[250:251] op_sel:[0,1]
v_pk_mul_f32 v[160:161], v[160:161], v[172:173]
v_cvt_pk_bf16_f32 v134, v160, v161
v_pk_fma_f32 v[162:163], v[250:251], v[234:235], v[162:163] op_sel_hi:[0,1,1]
v_pk_fma_f32 v[174:175], v[250:251], v[246:247], v[174:175] op_sel_hi:[0,1,1]
v_max_f32 v162, 0, v162
v_max_f32 v163, 0, v163
Lpd4_10:
s_cbranch_execz Lpd4_11
v_pk_mul_f32 v[174:175], v[174:175], v[250:251] op_sel:[0,1]
v_pk_mul_f32 v[162:163], v[162:163], v[174:175]
v_cvt_pk_bf16_f32 v135, v162, v163
v_permlane32_swap_b32 v132, v134
s_nop 0
v_permlane32_swap_b32 v133, v135
s_add_u32 s51, s50, 0
buffer_store_dwordx4 v[132:135], v7, s[40:43], s51 offen offset:1024 sc1
v_pk_fma_f32 v[176:177], v[252:253], v[224:225], v[176:177] op_sel_hi:[0,1,1]
v_pk_fma_f32 v[188:189], v[252:253], v[236:237], v[188:189] op_sel_hi:[0,1,1]
v_max_f32 v176, 0, v176
Lpd4_11:
s_cbranch_execz Lpd4_12
v_max_f32 v177, 0, v177
v_pk_mul_f32 v[188:189], v[188:189], v[252:253] op_sel:[0,1]
v_pk_mul_f32 v[176:177], v[176:177], v[188:189]
v_cvt_pk_bf16_f32 v176, v176, v177
v_pk_fma_f32 v[178:179], v[252:253], v[226:227], v[178:179] op_sel_hi:[0,1,1]
v_pk_fma_f32 v[190:191], v[252:253], v[238:239], v[190:191] op_sel_hi:[0,1,1]
v_max_f32 v178, 0, v178
v_max_f32 v179, 0, v179
v_pk_mul_f32 v[190:191], v[190:191], v[252:253] op_sel:[0,1]
v_pk_mul_f32 v[178:179], v[178:179], v[190:191]
Lpd4_12:
s_cbranch_execz Lpd4_13
v_cvt_pk_bf16_f32 v177, v178, v179
v_pk_fma_f32 v[180:181], v[252:253], v[228:229], v[180:181] op_sel_hi:[0,1,1]
v_pk_fma_f32 v[192:193], v[252:253], v[240:241], v[192:193] op_sel_hi:[0,1,1]
v_max_f32 v180, 0, v180
v_max_f32 v181, 0, v181
v_pk_mul_f32 v[192:193], v[192:193], v[252:253] op_sel:[0,1]
v_pk_mul_f32 v[180:181], v[180:181], v[192:193]
v_cvt_pk_bf16_f32 v178, v180, v181
v_pk_fma_f32 v[182:183], v[252:253], v[230:231], v[182:183] op_sel_hi:[0,1,1]
v_pk_fma_f32 v[194:195], v[252:253], v[242:243], v[194:195] op_sel_hi:[0,1,1]
Lpd4_13:
s_cbranch_execz Lpd4_14
v_max_f32 v182, 0, v182
v_max_f32 v183, 0, v183
v_pk_mul_f32 v[194:195], v[194:195], v[252:253] op_sel:[0,1]
v_pk_mul_f32 v[182:183], v[182:183], v[194:195]
v_cvt_pk_bf16_f32 v179, v182, v183
v_permlane32_swap_b32 v176, v178
s_nop 0
v_permlane32_swap_b32 v177, v179
s_add_u32 s51, s50, 98304
buffer_store_dwordx4 v[176:179], v3, s[40:43], s51 offen sc1
v_pk_fma_f32 v[184:185], v[252:253], v[232:233], v[184:185] op_sel_hi:[0,1,1]
Lpd4_14:
s_cbranch_execz Lpd4_15
v_pk_fma_f32 v[196:197], v[252:253], v[244:245], v[196:197] op_sel_hi:[0,1,1]
v_max_f32 v184, 0, v184
v_max_f32 v185, 0, v185
v_pk_mul_f32 v[196:197], v[196:197], v[252:253] op_sel:[0,1]
v_pk_mul_f32 v[184:185], v[184:185], v[196:197]
v_cvt_pk_bf16_f32 v180, v184, v185
v_pk_fma_f32 v[186:187], v[252:253], v[234:235], v[186:187] op_sel_hi:[0,1,1]
v_pk_fma_f32 v[198:199], v[252:253], v[246:247], v[198:199] op_sel_hi:[0,1,1]
v_max_f32 v186, 0, v186
v_max_f32 v187, 0, v187
Lpd4_15:
s_cbranch_execz Lpd4_16
v_pk_mul_f32 v[198:199], v[198:199], v[252:253] op_sel:[0,1]
v_pk_mul_f32 v[186:187], v[186:187], v[198:199]
v_cvt_pk_bf16_f32 v181, v186, v187
v_pk_fma_f32 v[200:201], v[254:255], v[224:225], v[200:201] op_sel_hi:[0,1,1]
v_pk_fma_f32 v[212:213], v[254:255], v[236:237], v[212:213] op_sel_hi:[0,1,1]
v_max_f32 v200, 0, v200
v_max_f32 v201, 0, v201
v_pk_mul_f32 v[212:213], v[212:213], v[254:255] op_sel:[0,1]
v_pk_mul_f32 v[200:201], v[200:201], v[212:213]
v_cvt_pk_bf16_f32 v200, v200, v201
Lpd4_16:
s_cbranch_execz Ldr4
v_pk_fma_f32 v[202:203], v[254:255], v[226:227], v[202:203] op_sel_hi:[0,1,1]
v_pk_fma_f32 v[214:215], v[254:255], v[238:239], v[214:215] op_sel_hi:[0,1,1]
v_max_f32 v202, 0, v202
v_max_f32 v203, 0, v203
v_pk_mul_f32 v[214:215], v[214:215], v[254:255] op_sel:[0,1]
v_pk_mul_f32 v[202:203], v[202:203], v[214:215]
v_cvt_pk_bf16_f32 v201, v202, v203
v_pk_fma_f32 v[204:205], v[254:255], v[228:229], v[204:205] op_sel_hi:[0,1,1]
v_pk_fma_f32 v[216:217], v[254:255], v[240:241], v[216:217] op_sel_hi:[0,1,1]
v_max_f32 v204, 0, v204
Ldt41:
Lpd4_17:
s_cbranch_execz Lpd4_18
v_max_f32 v205, 0, v205
v_pk_mul_f32 v[216:217], v[216:217], v[254:255] op_sel:[0,1]
v_pk_mul_f32 v[204:205], v[204:205], v[216:217]
v_cvt_pk_bf16_f32 v202, v204, v205
v_pk_fma_f32 v[206:207], v[254:255], v[230:231], v[206:207] op_sel_hi:[0,1,1]
v_pk_fma_f32 v[218:219], v[254:255], v[242:243], v[218:219] op_sel_hi:[0,1,1]
v_max_f32 v206, 0, v206
v_max_f32 v207, 0, v207
v_pk_mul_f32 v[218:219], v[218:219], v[254:255] op_sel:[0,1]
v_pk_mul_f32 v[206:207], v[206:207], v[218:219]
Lpd4_18:
s_cbranch_execz Lpd4_19
v_cvt_pk_bf16_f32 v203, v206, v207
v_permlane32_swap_b32 v200, v202
s_nop 0
v_permlane32_swap_b32 v201, v203
s_add_u32 s51, s50, 147456
buffer_store_dwordx4 v[200:203], v3, s[40:43], s51 offen sc1
v_pk_fma_f32 v[208:209], v[254:255], v[232:233], v[208:209] op_sel_hi:[0,1,1]
v_pk_fma_f32 v[220:221], v[254:255], v[244:245], v[220:221] op_sel_hi:[0,1,1]
v_max_f32 v208, 0, v208
v_max_f32 v209, 0, v209
v_pk_mul_f32 v[220:221], v[220:221], v[254:255] op_sel:[0,1]
Lpd4_19:
s_cbranch_execz Lpd4_20
v_pk_mul_f32 v[208:209], v[208:209], v[220:221]
v_cvt_pk_bf16_f32 v182, v208, v209
v_pk_fma_f32 v[210:211], v[254:255], v[234:235], v[210:211] op_sel_hi:[0,1,1]
v_pk_fma_f32 v[222:223], v[254:255], v[246:247], v[222:223] op_sel_hi:[0,1,1]
v_max_f32 v210, 0, v210
v_max_f32 v211, 0, v211
v_pk_mul_f32 v[222:223], v[222:223], v[254:255] op_sel:[0,1]
v_pk_mul_f32 v[210:211], v[210:211], v[222:223]
v_cvt_pk_bf16_f32 v183, v210, v211
v_permlane32_swap_b32 v180, v182
Lpd4_20:
s_cbranch_execz Lpd4_21
v_permlane32_swap_b32 v181, v183
s_add_u32 s51, s50, 98304
buffer_store_dwordx4 v[180:183], v7, s[40:43], s51 offen offset:1024 sc1
buffer_load_dwordx4 v[16:19], v3, s[40:43], s66 offen offset:0 sc1
buffer_load_dwordx4 v[20:23], v3, s[40:43], s67 offen offset:0 sc1
buffer_load_dwordx4 v[24:27], v3, s[40:43], s68 offen offset:0 sc1
buffer_load_dwordx4 v[28:31], v3, s[40:43], s69 offen offset:0 sc1
buffer_load_dwordx4 v[32:35], v3, s[40:43], s70 offen offset:0 sc1
s_mul_i32 s30, s78, 40960
v_add_u32 v4, s30, v3
Lpd4_21:
s_cbranch_execz Lpd4_22
s_sub_u32 s30, s78, 1
s_and_b32 s30, s30, 3
s_mul_i32 s30, s30, 40960
v_add_u32 v5, s30, v3
s_sub_u32 s30, s78, 2
s_and_b32 s30, s30, 3
s_mul_i32 s30, s30, 40960
v_add_u32 v6, s30, v3
s_sub_u32 s30, s78, 3
s_and_b32 s30, s30, 3
Lpd4_22:
s_cbranch_execz Lpd4_23
s_mul_i32 s30, s30, 40960
v_add_u32 v7, s30, v3
s_waitcnt vmcnt(5)
s_barrier
buffer_load_dwordx4 v[36:39], v3, s[40:43], s66 offen offset:1024 sc1
buffer_load_dwordx4 v[40:43], v3, s[40:43], s67 offen offset:1024 sc1
buffer_load_dwordx4 v[44:47], v3, s[40:43], s68 offen offset:1024 sc1
buffer_load_dwordx4 v[48:51], v3, s[40:43], s69 offen offset:1024 sc1
buffer_load_dwordx4 v[52:55], v3, s[40:43], s70 offen offset:1024 sc1
buffer_load_dwordx4 v[56:59], v3, s[40:43], s66 offen offset:2048 sc1
Lpd4_23:
s_cbranch_execz Lpd4_24
buffer_load_dwordx4 v[60:63], v3, s[40:43], s67 offen offset:2048 sc1
buffer_load_dwordx4 v[64:67], v3, s[40:43], s68 offen offset:2048 sc1
buffer_load_dwordx4 v[68:71], v3, s[40:43], s69 offen offset:2048 sc1
buffer_load_dwordx4 v[72:75], v3, s[40:43], s70 offen offset:2048 sc1
buffer_load_dwordx4 v[76:79], v3, s[40:43], s66 offen offset:3072 sc1
buffer_load_dwordx4 v[80:83], v3, s[40:43], s67 offen offset:3072 sc1
buffer_load_dwordx4 v[84:87], v3, s[40:43], s68 offen offset:3072 sc1
buffer_load_dwordx4 v[88:91], v3, s[40:43], s69 offen offset:3072 sc1
buffer_load_dwordx4 v[92:95], v3, s[40:43], s70 offen offset:3072 sc1
s_barrier
Lpd4_24:
s_cbranch_execz Lpd4_25
buffer_load_dwordx4 v[208:211], v3, s[40:43], s71 offen offset:0 sc1
buffer_load_dwordx4 v[212:215], v3, s[40:43], s72 offen offset:0 sc1
buffer_load_dwordx4 v[216:219], v3, s[40:43], s73 offen offset:0 sc1
buffer_load_dwordx4 v[220:223], v3, s[40:43], s74 offen offset:0 sc1
buffer_load_dwordx4 v[224:227], v3, s[40:43], s71 offen offset:1024 sc1
buffer_load_dwordx4 v[228:231], v3, s[40:43], s72 offen offset:1024 sc1
buffer_load_dwordx4 v[232:235], v3, s[40:43], s73 offen offset:1024 sc1
buffer_load_dwordx4 v[236:239], v3, s[40:43], s74 offen offset:1024 sc1
buffer_load_dwordx4 v[240:243], v3, s[40:43], s71 offen offset:2048 sc1
buffer_load_dwordx4 v[244:247], v3, s[40:43], s72 offen offset:2048 sc1
Lpd4_25:
s_cbranch_execz Lpd4_26
buffer_load_dwordx4 v[248:251], v3, s[40:43], s73 offen offset:2048 sc1
buffer_load_dwordx4 v[252:255], v3, s[40:43], s74 offen offset:2048 sc1
buffer_load_dwordx4 v[96:99], v3, s[40:43], s71 offen offset:3072 sc1
s_add_u32 s71, s71, 4096
buffer_load_dwordx4 v[100:103], v3, s[40:43], s72 offen offset:3072 sc1
s_add_u32 s72, s72, 4096
buffer_load_dwordx4 v[104:107], v3, s[40:43], s73 offen offset:3072 sc1
s_add_u32 s73, s73, 4096
buffer_load_dwordx4 v[108:111], v3, s[40:43], s74 offen offset:3072 sc1
s_add_u32 s74, s74, 4096
Lpd4_26:
s_cbranch_execz Lpd4_27
s_waitcnt vmcnt(12)
v_mfma_f32_16x16x32_bf16 v[128:131], v[16:19], v[208:211], 0
v_mfma_f32_16x16x32_bf16 v[132:135], v[20:23], v[208:211], 0
v_mfma_f32_16x16x32_bf16 v[136:139], v[24:27], v[208:211], 0
v_mfma_f32_16x16x32_bf16 v[140:143], v[28:31], v[208:211], 0
v_mfma_f32_16x16x32_bf16 v[144:147], v[32:35], v[208:211], 0
v_mfma_f32_16x16x32_bf16 v[148:151], v[16:19], v[212:215], 0
v_mfma_f32_16x16x32_bf16 v[152:155], v[20:23], v[212:215], 0
v_mfma_f32_16x16x32_bf16 v[156:159], v[24:27], v[212:215], 0
v_mfma_f32_16x16x32_bf16 v[160:163], v[28:31], v[212:215], 0
Lpd4_27:
s_cbranch_execz Lpd4_28
v_mfma_f32_16x16x32_bf16 v[164:167], v[32:35], v[212:215], 0
v_mfma_f32_16x16x32_bf16 v[168:171], v[16:19], v[216:219], 0
v_mfma_f32_16x16x32_bf16 v[172:175], v[20:23], v[216:219], 0
v_mfma_f32_16x16x32_bf16 v[176:179], v[24:27], v[216:219], 0
v_mfma_f32_16x16x32_bf16 v[180:183], v[28:31], v[216:219], 0
v_mfma_f32_16x16x32_bf16 v[184:187], v[32:35], v[216:219], 0
v_mfma_f32_16x16x32_bf16 v[188:191], v[16:19], v[220:223], 0
v_mfma_f32_16x16x32_bf16 v[192:195], v[20:23], v[220:223], 0
v_mfma_f32_16x16x32_bf16 v[196:199], v[24:27], v[220:223], 0
v_mfma_f32_16x16x32_bf16 v[200:203], v[28:31], v[220:223], 0
Lpd4_28:
s_cbranch_execz Lpd4_29
v_mfma_f32_16x16x32_bf16 v[204:207], v[32:35], v[220:223], 0
s_waitcnt vmcnt(8)
v_mfma_f32_16x16x32_bf16 v[128:131], v[36:39], v[224:227], v[128:131]
buffer_load_dwordx4 v[208:211], v3, s[40:43], s71 offen offset:0 sc1
v_mfma_f32_16x16x32_bf16 v[132:135], v[40:43], v[224:227], v[132:135]
buffer_load_dwordx4 v[212:215], v3, s[40:43], s72 offen offset:0 sc1
v_mfma_f32_16x16x32_bf16 v[136:139], v[44:47], v[224:227], v[136:139]
buffer_load_dwordx4 v[216:219], v3, s[40:43], s73 offen offset:0 sc1
v_mfma_f32_16x16x32_bf16 v[140:143], v[48:51], v[224:227], v[140:143]
buffer_load_dwordx4 v[220:223], v3, s[40:43], s74 offen offset:0 sc1
Lpd4_29:
s_cbranch_execz Lpd4_30
v_mfma_f32_16x16x32_bf16 v[144:147], v[52:55], v[224:227], v[144:147]
ds_read_b128 v[16:19], v4 offset:20480
v_mfma_f32_16x16x32_bf16 v[148:151], v[36:39], v[228:231], v[148:151]
ds_read_b128 v[20:23], v4 offset:21504
v_mfma_f32_16x16x32_bf16 v[152:155], v[40:43], v[228:231], v[152:155]
ds_read_b128 v[24:27], v4 offset:22528
v_mfma_f32_16x16x32_bf16 v[156:159], v[44:47], v[228:231], v[156:159]
ds_read_b128 v[28:31], v4 offset:23552
v_mfma_f32_16x16x32_bf16 v[160:163], v[48:51], v[228:231], v[160:163]
ds_read_b128 v[32:35], v4 offset:24576
Lpd4_30:
s_cbranch_execz Lpd4_31
v_mfma_f32_16x16x32_bf16 v[164:167], v[52:55], v[228:231], v[164:167]
v_mfma_f32_16x16x32_bf16 v[168:171], v[36:39], v[232:235], v[168:171]
v_mfma_f32_16x16x32_bf16 v[172:175], v[40:43], v[232:235], v[172:175]
v_mfma_f32_16x16x32_bf16 v[176:179], v[44:47], v[232:235], v[176:179]
v_mfma_f32_16x16x32_bf16 v[180:183], v[48:51], v[232:235], v[180:183]
v_mfma_f32_16x16x32_bf16 v[184:187], v[52:55], v[232:235], v[184:187]
v_mfma_f32_16x16x32_bf16 v[188:191], v[36:39], v[236:239], v[188:191]
v_mfma_f32_16x16x32_bf16 v[192:195], v[40:43], v[236:239], v[192:195]
v_mfma_f32_16x16x32_bf16 v[196:199], v[44:47], v[236:239], v[196:199]
v_mfma_f32_16x16x32_bf16 v[200:203], v[48:51], v[236:239], v[200:203]
Lpd4_31:
s_cbranch_execz Lpd4_32
v_mfma_f32_16x16x32_bf16 v[204:207], v[52:55], v[236:239], v[204:207]
s_waitcnt vmcnt(8)
v_mfma_f32_16x16x32_bf16 v[128:131], v[56:59], v[240:243], v[128:131]
buffer_load_dwordx4 v[224:227], v3, s[40:43], s71 offen offset:1024 sc1
v_mfma_f32_16x16x32_bf16 v[132:135], v[60:63], v[240:243], v[132:135]
buffer_load_dwordx4 v[228:231], v3, s[40:43], s72 offen offset:1024 sc1
v_mfma_f32_16x16x32_bf16 v[136:139], v[64:67], v[240:243], v[136:139]
buffer_load_dwordx4 v[232:235], v3, s[40:43], s73 offen offset:1024 sc1
v_mfma_f32_16x16x32_bf16 v[140:143], v[68:71], v[240:243], v[140:143]
buffer_load_dwordx4 v[236:239], v3, s[40:43], s74 offen offset:1024 sc1
Lpd4_32:
s_cbranch_execz Lpd4_33
v_mfma_f32_16x16x32_bf16 v[144:147], v[72:75], v[240:243], v[144:147]
ds_read_b128 v[36:39], v4 offset:25600
v_mfma_f32_16x16x32_bf16 v[148:151], v[56:59], v[244:247], v[148:151]
ds_read_b128 v[40:43], v4 offset:26624
v_mfma_f32_16x16x32_bf16 v[152:155], v[60:63], v[244:247], v[152:155]
ds_read_b128 v[44:47], v4 offset:27648
v_mfma_f32_16x16x32_bf16 v[156:159], v[64:67], v[244:247], v[156:159]
ds_read_b128 v[48:51], v4 offset:28672
v_mfma_f32_16x16x32_bf16 v[160:163], v[68:71], v[244:247], v[160:163]
ds_read_b128 v[52:55], v4 offset:29696
Lpd4_33:
s_cbranch_execz Lpd4_34
v_mfma_f32_16x16x32_bf16 v[164:167], v[72:75], v[244:247], v[164:167]
v_mfma_f32_16x16x32_bf16 v[168:171], v[56:59], v[248:251], v[168:171]
v_mfma_f32_16x16x32_bf16 v[172:175], v[60:63], v[248:251], v[172:175]
v_mfma_f32_16x16x32_bf16 v[176:179], v[64:67], v[248:251], v[176:179]
v_mfma_f32_16x16x32_bf16 v[180:183], v[68:71], v[248:251], v[180:183]
v_mfma_f32_16x16x32_bf16 v[184:187], v[72:75], v[248:251], v[184:187]
v_mfma_f32_16x16x32_bf16 v[188:191], v[56:59], v[252:255], v[188:191]
v_mfma_f32_16x16x32_bf16 v[192:195], v[60:63], v[252:255], v[192:195]
v_mfma_f32_16x16x32_bf16 v[196:199], v[64:67], v[252:255], v[196:199]
v_mfma_f32_16x16x32_bf16 v[200:203], v[68:71], v[252:255], v[200:203]
Lpd4_34:
s_cbranch_execz Ldr4
v_mfma_f32_16x16x32_bf16 v[204:207], v[72:75], v[252:255], v[204:207]
s_waitcnt vmcnt(8)
v_mfma_f32_16x16x32_bf16 v[128:131], v[76:79], v[96:99], v[128:131]
buffer_load_dwordx4 v[240:243], v3, s[40:43], s71 offen offset:2048 sc1
v_mfma_f32_16x16x32_bf16 v[132:135], v[80:83], v[96:99], v[132:135]
buffer_load_dwordx4 v[244:247], v3, s[40:43], s72 offen offset:2048 sc1
v_mfma_f32_16x16x32_bf16 v[136:139], v[84:87], v[96:99], v[136:139]
buffer_load_dwordx4 v[248:251], v3, s[40:43], s73 offen offset:2048 sc1
v_mfma_f32_16x16x32_bf16 v[140:143], v[88:91], v[96:99], v[140:143]
buffer_load_dwordx4 v[252:255], v3, s[40:43], s74 offen offset:2048 sc1
Ldt42:
Lpd4_35:
s_cbranch_execz Lpd4_36
v_mfma_f32_16x16x32_bf16 v[144:147], v[92:95], v[96:99], v[144:147]
ds_read_b128 v[56:59], v4 offset:30720
v_mfma_f32_16x16x32_bf16 v[148:151], v[76:79], v[100:103], v[148:151]
ds_read_b128 v[60:63], v4 offset:31744
v_mfma_f32_16x16x32_bf16 v[152:155], v[80:83], v[100:103], v[152:155]
ds_read_b128 v[64:67], v4 offset:32768
v_mfma_f32_16x16x32_bf16 v[156:159], v[84:87], v[100:103], v[156:159]
ds_read_b128 v[68:71], v4 offset:33792
v_mfma_f32_16x16x32_bf16 v[160:163], v[88:91], v[100:103], v[160:163]
ds_read_b128 v[72:75], v4 offset:34816
Lpd4_36:
s_cbranch_execz Lpd4_37
v_mfma_f32_16x16x32_bf16 v[164:167], v[92:95], v[100:103], v[164:167]
v_mfma_f32_16x16x32_bf16 v[168:171], v[76:79], v[104:107], v[168:171]
v_mfma_f32_16x16x32_bf16 v[172:175], v[80:83], v[104:107], v[172:175]
v_mfma_f32_16x16x32_bf16 v[176:179], v[84:87], v[104:107], v[176:179]
v_mfma_f32_16x16x32_bf16 v[180:183], v[88:91], v[104:107], v[180:183]
v_mfma_f32_16x16x32_bf16 v[184:187], v[92:95], v[104:107], v[184:187]
v_mfma_f32_16x16x32_bf16 v[188:191], v[76:79], v[108:111], v[188:191]
v_mfma_f32_16x16x32_bf16 v[192:195], v[80:83], v[108:111], v[192:195]
v_mfma_f32_16x16x32_bf16 v[196:199], v[84:87], v[108:111], v[196:199]
v_mfma_f32_16x16x32_bf16 v[200:203], v[88:91], v[108:111], v[200:203]
Lpd4_37:
s_cbranch_execz Lpd4_38
v_mfma_f32_16x16x32_bf16 v[204:207], v[92:95], v[108:111], v[204:207]
s_waitcnt vmcnt(8) lgkmcnt(10)
v_mfma_f32_16x16x32_bf16 v[128:131], v[16:19], v[208:211], v[128:131]
buffer_load_dwordx4 v[96:99], v3, s[40:43], s71 offen offset:3072 sc1
s_add_u32 s71, s71, 4096
v_mfma_f32_16x16x32_bf16 v[132:135], v[20:23], v[208:211], v[132:135]
buffer_load_dwordx4 v[100:103], v3, s[40:43], s72 offen offset:3072 sc1
s_add_u32 s72, s72, 4096
v_mfma_f32_16x16x32_bf16 v[136:139], v[24:27], v[208:211], v[136:139]
buffer_load_dwordx4 v[104:107], v3, s[40:43], s73 offen offset:3072 sc1
Lpd4_38:
s_cbranch_execz Lpd4_39
s_add_u32 s73, s73, 4096
v_mfma_f32_16x16x32_bf16 v[140:143], v[28:31], v[208:211], v[140:143]
buffer_load_dwordx4 v[108:111], v3, s[40:43], s74 offen offset:3072 sc1
s_add_u32 s74, s74, 4096
v_mfma_f32_16x16x32_bf16 v[144:147], v[32:35], v[208:211], v[144:147]
ds_read_b128 v[76:79], v4 offset:35840
v_mfma_f32_16x16x32_bf16 v[148:151], v[16:19], v[212:215], v[148:151]
ds_read_b128 v[80:83], v4 offset:36864
v_mfma_f32_16x16x32_bf16 v[152:155], v[20:23], v[212:215], v[152:155]
ds_read_b128 v[84:87], v4 offset:37888
Lpd4_39:
s_cbranch_execz Lpd4_40
v_mfma_f32_16x16x32_bf16 v[156:159], v[24:27], v[212:215], v[156:159]
ds_read_b128 v[88:91], v4 offset:38912
v_mfma_f32_16x16x32_bf16 v[160:163], v[28:31], v[212:215], v[160:163]
ds_read_b128 v[92:95], v4 offset:39936
v_mfma_f32_16x16x32_bf16 v[164:167], v[32:35], v[212:215], v[164:167]
v_mfma_f32_16x16x32_bf16 v[168:171], v[16:19], v[216:219], v[168:171]
v_mfma_f32_16x16x32_bf16 v[172:175], v[20:23], v[216:219], v[172:175]
v_mfma_f32_16x16x32_bf16 v[176:179], v[24:27], v[216:219], v[176:179]
v_mfma_f32_16x16x32_bf16 v[180:183], v[28:31], v[216:219], v[180:183]
v_mfma_f32_16x16x32_bf16 v[184:187], v[32:35], v[216:219], v[184:187]
Lpd4_40:
s_cbranch_execz Lpd4_41
v_mfma_f32_16x16x32_bf16 v[188:191], v[16:19], v[220:223], v[188:191]
v_mfma_f32_16x16x32_bf16 v[192:195], v[20:23], v[220:223], v[192:195]
v_mfma_f32_16x16x32_bf16 v[196:199], v[24:27], v[220:223], v[196:199]
v_mfma_f32_16x16x32_bf16 v[200:203], v[28:31], v[220:223], v[200:203]
v_mfma_f32_16x16x32_bf16 v[204:207], v[32:35], v[220:223], v[204:207]
s_waitcnt vmcnt(8) lgkmcnt(10)
v_mfma_f32_16x16x32_bf16 v[128:131], v[36:39], v[224:227], v[128:131]
buffer_load_dwordx4 v[208:211], v3, s[40:43], s71 offen offset:0 sc1
v_mfma_f32_16x16x32_bf16 v[132:135], v[40:43], v[224:227], v[132:135]
buffer_load_dwordx4 v[212:215], v3, s[40:43], s72 offen offset:0 sc1
Lpd4_41:
s_cbranch_execz Lpd4_42
v_mfma_f32_16x16x32_bf16 v[136:139], v[44:47], v[224:227], v[136:139]
buffer_load_dwordx4 v[216:219], v3, s[40:43], s73 offen offset:0 sc1
v_mfma_f32_16x16x32_bf16 v[140:143], v[48:51], v[224:227], v[140:143]
buffer_load_dwordx4 v[220:223], v3, s[40:43], s74 offen offset:0 sc1
v_mfma_f32_16x16x32_bf16 v[144:147], v[52:55], v[224:227], v[144:147]
ds_read_b128 v[16:19], v4 offset:0
v_mfma_f32_16x16x32_bf16 v[148:151], v[36:39], v[228:231], v[148:151]
ds_read_b128 v[20:23], v4 offset:1024
v_mfma_f32_16x16x32_bf16 v[152:155], v[40:43], v[228:231], v[152:155]
ds_read_b128 v[24:27], v4 offset:2048
Lpd4_42:
s_cbranch_execz Lpd4_43
v_mfma_f32_16x16x32_bf16 v[156:159], v[44:47], v[228:231], v[156:159]
ds_read_b128 v[28:31], v4 offset:3072
v_mfma_f32_16x16x32_bf16 v[160:163], v[48:51], v[228:231], v[160:163]
ds_read_b128 v[32:35], v4 offset:4096
v_mfma_f32_16x16x32_bf16 v[164:167], v[52:55], v[228:231], v[164:167]
v_mfma_f32_16x16x32_bf16 v[168:171], v[36:39], v[232:235], v[168:171]
v_mfma_f32_16x16x32_bf16 v[172:175], v[40:43], v[232:235], v[172:175]
v_mfma_f32_16x16x32_bf16 v[176:179], v[44:47], v[232:235], v[176:179]
v_mfma_f32_16x16x32_bf16 v[180:183], v[48:51], v[232:235], v[180:183]
v_mfma_f32_16x16x32_bf16 v[184:187], v[52:55], v[232:235], v[184:187]
Lpd4_43:
s_cbranch_execz Lpd4_44
v_mfma_f32_16x16x32_bf16 v[188:191], v[36:39], v[236:239], v[188:191]
v_mfma_f32_16x16x32_bf16 v[192:195], v[40:43], v[236:239], v[192:195]
v_mfma_f32_16x16x32_bf16 v[196:199], v[44:47], v[236:239], v[196:199]
v_mfma_f32_16x16x32_bf16 v[200:203], v[48:51], v[236:239], v[200:203]
v_mfma_f32_16x16x32_bf16 v[204:207], v[52:55], v[236:239], v[204:207]
s_waitcnt vmcnt(8) lgkmcnt(10)
v_mfma_f32_16x16x32_bf16 v[128:131], v[56:59], v[240:243], v[128:131]
buffer_load_dwordx4 v[224:227], v3, s[40:43], s71 offen offset:1024 sc1
v_mfma_f32_16x16x32_bf16 v[132:135], v[60:63], v[240:243], v[132:135]
buffer_load_dwordx4 v[228:231], v3, s[40:43], s72 offen offset:1024 sc1
Lpd4_44:
s_cbranch_execz Lpd4_45
v_mfma_f32_16x16x32_bf16 v[136:139], v[64:67], v[240:243], v[136:139]
buffer_load_dwordx4 v[232:235], v3, s[40:43], s73 offen offset:1024 sc1
v_mfma_f32_16x16x32_bf16 v[140:143], v[68:71], v[240:243], v[140:143]
buffer_load_dwordx4 v[236:239], v3, s[40:43], s74 offen offset:1024 sc1
v_mfma_f32_16x16x32_bf16 v[144:147], v[72:75], v[240:243], v[144:147]
ds_read_b128 v[36:39], v4 offset:5120
v_mfma_f32_16x16x32_bf16 v[148:151], v[56:59], v[244:247], v[148:151]
ds_read_b128 v[40:43], v4 offset:6144
v_mfma_f32_16x16x32_bf16 v[152:155], v[60:63], v[244:247], v[152:155]
ds_read_b128 v[44:47], v4 offset:7168
Lpd4_45:
s_cbranch_execz Lpd4_46
v_mfma_f32_16x16x32_bf16 v[156:159], v[64:67], v[244:247], v[156:159]
ds_read_b128 v[48:51], v4 offset:8192
v_mfma_f32_16x16x32_bf16 v[160:163], v[68:71], v[244:247], v[160:163]
ds_read_b128 v[52:55], v4 offset:9216
v_mfma_f32_16x16x32_bf16 v[164:167], v[72:75], v[244:247], v[164:167]
v_mfma_f32_16x16x32_bf16 v[168:171], v[56:59], v[248:251], v[168:171]
v_mfma_f32_16x16x32_bf16 v[172:175], v[60:63], v[248:251], v[172:175]
v_mfma_f32_16x16x32_bf16 v[176:179], v[64:67], v[248:251], v[176:179]
v_mfma_f32_16x16x32_bf16 v[180:183], v[68:71], v[248:251], v[180:183]
v_mfma_f32_16x16x32_bf16 v[184:187], v[72:75], v[248:251], v[184:187]
Lpd4_46:
s_cbranch_execz Lpd4_47
v_mfma_f32_16x16x32_bf16 v[188:191], v[56:59], v[252:255], v[188:191]
v_mfma_f32_16x16x32_bf16 v[192:195], v[60:63], v[252:255], v[192:195]
v_mfma_f32_16x16x32_bf16 v[196:199], v[64:67], v[252:255], v[196:199]
v_mfma_f32_16x16x32_bf16 v[200:203], v[68:71], v[252:255], v[200:203]
v_mfma_f32_16x16x32_bf16 v[204:207], v[72:75], v[252:255], v[204:207]
s_waitcnt vmcnt(8) lgkmcnt(10)
v_mfma_f32_16x16x32_bf16 v[128:131], v[76:79], v[96:99], v[128:131]
buffer_load_dwordx4 v[240:243], v3, s[40:43], s71 offen offset:2048 sc1
v_mfma_f32_16x16x32_bf16 v[132:135], v[80:83], v[96:99], v[132:135]
buffer_load_dwordx4 v[244:247], v3, s[40:43], s72 offen offset:2048 sc1
Lpd4_47:
s_cbranch_execz Lpd4_48
v_mfma_f32_16x16x32_bf16 v[136:139], v[84:87], v[96:99], v[136:139]
buffer_load_dwordx4 v[248:251], v3, s[40:43], s73 offen offset:2048 sc1
v_mfma_f32_16x16x32_bf16 v[140:143], v[88:91], v[96:99], v[140:143]
buffer_load_dwordx4 v[252:255], v3, s[40:43], s74 offen offset:2048 sc1
v_mfma_f32_16x16x32_bf16 v[144:147], v[92:95], v[96:99], v[144:147]
ds_read_b128 v[56:59], v4 offset:10240
v_mfma_f32_16x16x32_bf16 v[148:151], v[76:79], v[100:103], v[148:151]
ds_read_b128 v[60:63], v4 offset:11264
v_mfma_f32_16x16x32_bf16 v[152:155], v[80:83], v[100:103], v[152:155]
ds_read_b128 v[64:67], v4 offset:12288
Lpd4_48:
s_cbranch_execz Lpd4_49
v_mfma_f32_16x16x32_bf16 v[156:159], v[84:87], v[100:103], v[156:159]
ds_read_b128 v[68:71], v4 offset:13312
v_mfma_f32_16x16x32_bf16 v[160:163], v[88:91], v[100:103], v[160:163]
ds_read_b128 v[72:75], v4 offset:14336
v_mfma_f32_16x16x32_bf16 v[164:167], v[92:95], v[100:103], v[164:167]
v_mfma_f32_16x16x32_bf16 v[168:171], v[76:79], v[104:107], v[168:171]
v_mfma_f32_16x16x32_bf16 v[172:175], v[80:83], v[104:107], v[172:175]
v_mfma_f32_16x16x32_bf16 v[176:179], v[84:87], v[104:107], v[176:179]
v_mfma_f32_16x16x32_bf16 v[180:183], v[88:91], v[104:107], v[180:183]
v_mfma_f32_16x16x32_bf16 v[184:187], v[92:95], v[104:107], v[184:187]
Lpd4_49:
s_cbranch_execz Lpd4_50
v_mfma_f32_16x16x32_bf16 v[188:191], v[76:79], v[108:111], v[188:191]
v_mfma_f32_16x16x32_bf16 v[192:195], v[80:83], v[108:111], v[192:195]
v_mfma_f32_16x16x32_bf16 v[196:199], v[84:87], v[108:111], v[196:199]
v_mfma_f32_16x16x32_bf16 v[200:203], v[88:91], v[108:111], v[200:203]
v_mfma_f32_16x16x32_bf16 v[204:207], v[92:95], v[108:111], v[204:207]
s_waitcnt vmcnt(8) lgkmcnt(10)
v_mfma_f32_16x16x32_bf16 v[128:131], v[16:19], v[208:211], v[128:131]
buffer_load_dwordx4 v[96:99], v3, s[40:43], s71 offen offset:3072 sc1
s_add_u32 s71, s71, 4096
v_mfma_f32_16x16x32_bf16 v[132:135], v[20:23], v[208:211], v[132:135]
Lpd4_50:
s_cbranch_execz Lpd4_51
buffer_load_dwordx4 v[100:103], v3, s[40:43], s72 offen offset:3072 sc1
s_add_u32 s72, s72, 4096
v_mfma_f32_16x16x32_bf16 v[136:139], v[24:27], v[208:211], v[136:139]
buffer_load_dwordx4 v[104:107], v3, s[40:43], s73 offen offset:3072 sc1
s_add_u32 s73, s73, 4096
v_mfma_f32_16x16x32_bf16 v[140:143], v[28:31], v[208:211], v[140:143]
buffer_load_dwordx4 v[108:111], v3, s[40:43], s74 offen offset:3072 sc1
s_add_u32 s74, s74, 4096
v_mfma_f32_16x16x32_bf16 v[144:147], v[32:35], v[208:211], v[144:147]
ds_read_b128 v[76:79], v4 offset:15360
Lpd4_51:
s_cbranch_execz Lpd4_52
v_mfma_f32_16x16x32_bf16 v[148:151], v[16:19], v[212:215], v[148:151]
ds_read_b128 v[80:83], v4 offset:16384
v_mfma_f32_16x16x32_bf16 v[152:155], v[20:23], v[212:215], v[152:155]
ds_read_b128 v[84:87], v4 offset:17408
v_mfma_f32_16x16x32_bf16 v[156:159], v[24:27], v[212:215], v[156:159]
ds_read_b128 v[88:91], v4 offset:18432
v_mfma_f32_16x16x32_bf16 v[160:163], v[28:31], v[212:215], v[160:163]
ds_read_b128 v[92:95], v4 offset:19456
v_mfma_f32_16x16x32_bf16 v[164:167], v[32:35], v[212:215], v[164:167]
v_mfma_f32_16x16x32_bf16 v[168:171], v[16:19], v[216:219], v[168:171]
Lpd4_52:
s_cbranch_execz Ldr4
v_mfma_f32_16x16x32_bf16 v[172:175], v[20:23], v[216:219], v[172:175]
v_mfma_f32_16x16x32_bf16 v[176:179], v[24:27], v[216:219], v[176:179]
v_mfma_f32_16x16x32_bf16 v[180:183], v[28:31], v[216:219], v[180:183]
v_mfma_f32_16x16x32_bf16 v[184:187], v[32:35], v[216:219], v[184:187]
v_mfma_f32_16x16x32_bf16 v[188:191], v[16:19], v[220:223], v[188:191]
v_mfma_f32_16x16x32_bf16 v[192:195], v[20:23], v[220:223], v[192:195]
v_mfma_f32_16x16x32_bf16 v[196:199], v[24:27], v[220:223], v[196:199]
v_mfma_f32_16x16x32_bf16 v[200:203], v[28:31], v[220:223], v[200:203]
v_mfma_f32_16x16x32_bf16 v[204:207], v[32:35], v[220:223], v[204:207]
s_waitcnt vmcnt(8) lgkmcnt(10)
Ldt43:
Lpd4_53:
s_cbranch_execz Lpd4_54
v_mfma_f32_16x16x32_bf16 v[128:131], v[36:39], v[224:227], v[128:131]
v_mfma_f32_16x16x32_bf16 v[132:135], v[40:43], v[224:227], v[132:135]
v_mfma_f32_16x16x32_bf16 v[136:139], v[44:47], v[224:227], v[136:139]
v_mfma_f32_16x16x32_bf16 v[140:143], v[48:51], v[224:227], v[140:143]
v_mfma_f32_16x16x32_bf16 v[144:147], v[52:55], v[224:227], v[144:147]
v_mfma_f32_16x16x32_bf16 v[148:151], v[36:39], v[228:231], v[148:151]
v_mfma_f32_16x16x32_bf16 v[152:155], v[40:43], v[228:231], v[152:155]
v_mfma_f32_16x16x32_bf16 v[156:159], v[44:47], v[228:231], v[156:159]
v_mfma_f32_16x16x32_bf16 v[160:163], v[48:51], v[228:231], v[160:163]
v_mfma_f32_16x16x32_bf16 v[164:167], v[52:55], v[228:231], v[164:167]
Lpd4_54:
s_cbranch_execz Lpd4_55
v_mfma_f32_16x16x32_bf16 v[168:171], v[36:39], v[232:235], v[168:171]
v_mfma_f32_16x16x32_bf16 v[172:175], v[40:43], v[232:235], v[172:175]
v_mfma_f32_16x16x32_bf16 v[176:179], v[44:47], v[232:235], v[176:179]
v_mfma_f32_16x16x32_bf16 v[180:183], v[48:51], v[232:235], v[180:183]
v_mfma_f32_16x16x32_bf16 v[184:187], v[52:55], v[232:235], v[184:187]
v_mfma_f32_16x16x32_bf16 v[188:191], v[36:39], v[236:239], v[188:191]
v_mfma_f32_16x16x32_bf16 v[192:195], v[40:43], v[236:239], v[192:195]
v_mfma_f32_16x16x32_bf16 v[196:199], v[44:47], v[236:239], v[196:199]
v_mfma_f32_16x16x32_bf16 v[200:203], v[48:51], v[236:239], v[200:203]
v_mfma_f32_16x16x32_bf16 v[204:207], v[52:55], v[236:239], v[204:207]
Lpd4_55:
s_cbranch_execz Lpd4_56
s_waitcnt vmcnt(4) lgkmcnt(5)
v_mfma_f32_16x16x32_bf16 v[128:131], v[56:59], v[240:243], v[128:131]
v_mfma_f32_16x16x32_bf16 v[132:135], v[60:63], v[240:243], v[132:135]
v_mfma_f32_16x16x32_bf16 v[136:139], v[64:67], v[240:243], v[136:139]
v_mfma_f32_16x16x32_bf16 v[140:143], v[68:71], v[240:243], v[140:143]
v_mfma_f32_16x16x32_bf16 v[144:147], v[72:75], v[240:243], v[144:147]
v_mfma_f32_16x16x32_bf16 v[148:151], v[56:59], v[244:247], v[148:151]
v_mfma_f32_16x16x32_bf16 v[152:155], v[60:63], v[244:247], v[152:155]
v_mfma_f32_16x16x32_bf16 v[156:159], v[64:67], v[244:247], v[156:159]
v_mfma_f32_16x16x32_bf16 v[160:163], v[68:71], v[244:247], v[160:163]
Lpd4_56:
s_cbranch_execz Lpd4_57
v_mfma_f32_16x16x32_bf16 v[164:167], v[72:75], v[244:247], v[164:167]
v_mfma_f32_16x16x32_bf16 v[168:171], v[56:59], v[248:251], v[168:171]
v_mfma_f32_16x16x32_bf16 v[172:175], v[60:63], v[248:251], v[172:175]
v_mfma_f32_16x16x32_bf16 v[176:179], v[64:67], v[248:251], v[176:179]
v_mfma_f32_16x16x32_bf16 v[180:183], v[68:71], v[248:251], v[180:183]
v_mfma_f32_16x16x32_bf16 v[184:187], v[72:75], v[248:251], v[184:187]
v_mfma_f32_16x16x32_bf16 v[188:191], v[56:59], v[252:255], v[188:191]
v_mfma_f32_16x16x32_bf16 v[192:195], v[60:63], v[252:255], v[192:195]
v_mfma_f32_16x16x32_bf16 v[196:199], v[64:67], v[252:255], v[196:199]
v_mfma_f32_16x16x32_bf16 v[200:203], v[68:71], v[252:255], v[200:203]
Lpd4_57:
s_cbranch_execz Lpd4_58
v_mfma_f32_16x16x32_bf16 v[204:207], v[72:75], v[252:255], v[204:207]
s_waitcnt vmcnt(0) lgkmcnt(0)
v_mfma_f32_16x16x32_bf16 v[148:151], v[76:79], v[100:103], v[148:151]
v_mfma_f32_16x16x32_bf16 v[152:155], v[80:83], v[100:103], v[152:155]
v_mfma_f32_16x16x32_bf16 v[156:159], v[84:87], v[100:103], v[156:159]
v_mfma_f32_16x16x32_bf16 v[160:163], v[88:91], v[100:103], v[160:163]
v_mfma_f32_16x16x32_bf16 v[164:167], v[92:95], v[100:103], v[164:167]
v_mfma_f32_16x16x32_bf16 v[168:171], v[76:79], v[104:107], v[168:171]
s_nop 2
ds_write_b128 v4, v[148:151] offset:0
v_mfma_f32_16x16x32_bf16 v[172:175], v[80:83], v[104:107], v[172:175]
Lpd4_58:
s_cbranch_execz Lpd4_59
ds_write_b128 v4, v[152:155] offset:1024
v_mfma_f32_16x16x32_bf16 v[176:179], v[84:87], v[104:107], v[176:179]
ds_write_b128 v4, v[156:159] offset:2048
v_mfma_f32_16x16x32_bf16 v[180:183], v[88:91], v[104:107], v[180:183]
ds_write_b128 v4, v[160:163] offset:3072
v_mfma_f32_16x16x32_bf16 v[184:187], v[92:95], v[104:107], v[184:187]
ds_write_b128 v4, v[164:167] offset:4096
v_mfma_f32_16x16x32_bf16 v[188:191], v[76:79], v[108:111], v[188:191]
ds_write_b128 v4, v[168:171] offset:5120
v_mfma_f32_16x16x32_bf16 v[192:195], v[80:83], v[108:111], v[192:195]
Lpd4_59:
s_cbranch_execz Lpd4_60
ds_write_b128 v4, v[172:175] offset:6144
v_mfma_f32_16x16x32_bf16 v[196:199], v[84:87], v[108:111], v[196:199]
ds_write_b128 v4, v[176:179] offset:7168
v_mfma_f32_16x16x32_bf16 v[200:203], v[88:91], v[108:111], v[200:203]
ds_write_b128 v4, v[180:183] offset:8192
v_mfma_f32_16x16x32_bf16 v[204:207], v[92:95], v[108:111], v[204:207]
ds_write_b128 v4, v[184:187] offset:9216
v_mfma_f32_16x16x32_bf16 v[128:131], v[76:79], v[96:99], v[128:131]
ds_write_b128 v4, v[188:191] offset:10240
v_mfma_f32_16x16x32_bf16 v[132:135], v[80:83], v[96:99], v[132:135]
Lpd4_60:
s_cbranch_execz Lpd4_61
ds_write_b128 v4, v[192:195] offset:11264
v_mfma_f32_16x16x32_bf16 v[136:139], v[84:87], v[96:99], v[136:139]
ds_write_b128 v4, v[196:199] offset:12288
v_mfma_f32_16x16x32_bf16 v[140:143], v[88:91], v[96:99], v[140:143]
ds_write_b128 v4, v[200:203] offset:13312
v_mfma_f32_16x16x32_bf16 v[144:147], v[92:95], v[96:99], v[144:147]
ds_write_b128 v4, v[204:207] offset:14336
s_waitcnt lgkmcnt(0)
s_barrier
ds_read_b128 v[148:151], v5 offset:0
Lpd4_61:
s_cbranch_execz Lpd4_62
ds_read_b128 v[152:155], v6 offset:5120
ds_read_b128 v[156:159], v7 offset:10240
ds_read_b128 v[160:163], v5 offset:1024
ds_read_b128 v[164:167], v6 offset:6144
ds_read_b128 v[168:171], v7 offset:11264
ds_read_b128 v[172:175], v5 offset:2048
ds_read_b128 v[176:179], v6 offset:7168
ds_read_b128 v[180:183], v7 offset:12288
ds_read_b128 v[184:187], v5 offset:3072
ds_read_b128 v[188:191], v6 offset:8192
Lpd4_62:
s_cbranch_execz Lpd4_63
ds_read_b128 v[192:195], v7 offset:13312
ds_read_b128 v[196:199], v5 offset:4096
ds_read_b128 v[200:203], v6 offset:9216
ds_read_b128 v[204:207], v7 offset:14336
s_waitcnt vmcnt(0)
s_waitcnt lgkmcnt(12)
v_pk_add_f32 v[128:129], v[128:129], v[148:149]
v_pk_add_f32 v[152:153], v[152:153], v[156:157]
v_lshlrev_b32 v12, 16, v112
v_and_b32 v13, 0xffff0000, v112
Lpd4_63:
s_cbranch_execz Lpd4_64
v_pk_add_f32 v[128:129], v[128:129], v[152:153]
v_pk_add_f32 v[128:129], v[128:129], v[12:13]
v_cvt_pk_bf16_f32 v100, v128, v129
v_pk_add_f32 v[130:131], v[130:131], v[150:151]
v_pk_add_f32 v[154:155], v[154:155], v[158:159]
v_lshlrev_b32 v12, 16, v113
v_and_b32 v13, 0xffff0000, v113
v_pk_add_f32 v[130:131], v[130:131], v[154:155]
v_pk_add_f32 v[130:131], v[130:131], v[12:13]
v_cvt_pk_bf16_f32 v101, v130, v131
Lpd4_64:
s_cbranch_execz Lpd4_65
buffer_store_dwordx2 v[100:101], v14, s[44:47], s79 offen offset:0
s_waitcnt lgkmcnt(9)
v_pk_add_f32 v[132:133], v[132:133], v[160:161]
v_pk_add_f32 v[164:165], v[164:165], v[168:169]
v_lshlrev_b32 v12, 16, v114
v_and_b32 v13, 0xffff0000, v114
v_pk_add_f32 v[132:133], v[132:133], v[164:165]
v_pk_add_f32 v[132:133], v[132:133], v[12:13]
v_cvt_pk_bf16_f32 v102, v132, v133
v_pk_add_f32 v[134:135], v[134:135], v[162:163]
Lpd4_65:
s_cbranch_execz Lpd4_66
v_pk_add_f32 v[166:167], v[166:167], v[170:171]
v_lshlrev_b32 v12, 16, v115
v_and_b32 v13, 0xffff0000, v115
v_pk_add_f32 v[134:135], v[134:135], v[166:167]
v_pk_add_f32 v[134:135], v[134:135], v[12:13]
v_cvt_pk_bf16_f32 v103, v134, v135
buffer_store_dwordx2 v[102:103], v14, s[44:47], s79 offen offset:32
s_waitcnt lgkmcnt(6)
v_pk_add_f32 v[136:137], v[136:137], v[172:173]
v_pk_add_f32 v[176:177], v[176:177], v[180:181]
Lpd4_66:
s_cbranch_execz Lpd4_67
v_lshlrev_b32 v12, 16, v116
v_and_b32 v13, 0xffff0000, v116
v_pk_add_f32 v[136:137], v[136:137], v[176:177]
v_pk_add_f32 v[136:137], v[136:137], v[12:13]
v_cvt_pk_bf16_f32 v104, v136, v137
v_pk_add_f32 v[138:139], v[138:139], v[174:175]
v_pk_add_f32 v[178:179], v[178:179], v[182:183]
v_lshlrev_b32 v12, 16, v117
v_and_b32 v13, 0xffff0000, v117
v_pk_add_f32 v[138:139], v[138:139], v[178:179]
Lpd4_67:
s_cbranch_execz Lpd4_68
v_pk_add_f32 v[138:139], v[138:139], v[12:13]
v_cvt_pk_bf16_f32 v105, v138, v139
buffer_store_dwordx2 v[104:105], v14, s[44:47], s79 offen offset:64
s_waitcnt lgkmcnt(3)
v_pk_add_f32 v[140:141], v[140:141], v[184:185]
v_pk_add_f32 v[188:189], v[188:189], v[192:193]
v_lshlrev_b32 v12, 16, v118
v_and_b32 v13, 0xffff0000, v118
v_pk_add_f32 v[140:141], v[140:141], v[188:189]
v_pk_add_f32 v[140:141], v[140:141], v[12:13]
Lpd4_68:
s_cbranch_execz Lpd4_69
v_cvt_pk_bf16_f32 v106, v140, v141
v_pk_add_f32 v[142:143], v[142:143], v[186:187]
v_pk_add_f32 v[190:191], v[190:191], v[194:195]
v_lshlrev_b32 v12, 16, v119
v_and_b32 v13, 0xffff0000, v119
v_pk_add_f32 v[142:143], v[142:143], v[190:191]
v_pk_add_f32 v[142:143], v[142:143], v[12:13]
v_cvt_pk_bf16_f32 v107, v142, v143
buffer_store_dwordx2 v[106:107], v14, s[44:47], s79 offen offset:96
s_waitcnt lgkmcnt(0)
Lpd4_69:
s_cbranch_execz Lpd4_70
v_pk_add_f32 v[144:145], v[144:145], v[196:197]
v_pk_add_f32 v[200:201], v[200:201], v[204:205]
v_lshlrev_b32 v12, 16, v120
v_and_b32 v13, 0xffff0000, v120
v_pk_add_f32 v[144:145], v[144:145], v[200:201]
v_pk_add_f32 v[144:145], v[144:145], v[12:13]
v_cvt_pk_bf16_f32 v108, v144, v145
v_pk_add_f32 v[146:147], v[146:147], v[198:199]
v_pk_add_f32 v[202:203], v[202:203], v[206:207]
v_lshlrev_b32 v12, 16, v121
Lpd4_70:
s_cbranch_execz Ldr4
v_and_b32 v13, 0xffff0000, v121
v_pk_add_f32 v[146:147], v[146:147], v[202:203]
v_pk_add_f32 v[146:147], v[146:147], v[12:13]
v_cvt_pk_bf16_f32 v109, v146, v147
buffer_store_dwordx2 v[108:109], v14, s[44:47], s79 offen offset:128
Lend:
s_endpgm
.section .rodata,"a"
.p2align 6
.amdhsa_kernel sequential_preLN__linear_attn_block__glu_gated_reglu__prompt_kernel
  .amdhsa_next_free_vgpr 256
  .amdhsa_next_free_sgpr 102
  .amdhsa_accum_offset 256
  .amdhsa_group_segment_fixed_size 0
  .amdhsa_kernarg_size 80
  .amdhsa_user_sgpr_count 2
  .amdhsa_user_sgpr_kernarg_segment_ptr 1
  .amdhsa_system_sgpr_workgroup_id_x 1
.end_amdhsa_kernel
```
